```python
import torch

def _softmax(x, axis=-1):
    return torch.softmax(x, dim=axis)
def _gelu(x):
    return torch.nn.functional.gelu(x, approximate="tanh")
def _silu(x):
    return torch.nn.functional.silu(x)
def _sigmoid(x):
    return torch.sigmoid(x)
def _layernorm(x, axis=-1, eps=1e-5):
    m = x.mean(dim=axis, keepdim=True)
    v = x.var(dim=axis, keepdim=True, unbiased=False)
    return (x - m) / torch.sqrt(v + eps)
def _scatter_add(tgt, idx, src, axis=0):
    return tgt.clone().index_add_(axis, idx, src)
def _segment_sum(src, seg, n):
    out = torch.zeros((n,) + src.shape[1:], dtype=src.dtype)
    return out.index_add_(0, seg, src)
def _pad(x, pw):
    flat = tuple(v for pair in reversed(pw) for v in pair)
    return torch.nn.functional.pad(x, flat)

kernel_name = 'parallel_sum__ssm_conv_s5__glu_gated_glu__prompt'

def setup_inputs():

    _w = (lambda a: (lambda t: t.to(torch.bfloat16) if t.is_floating_point() else t)(torch.as_tensor(a)))
    def _A_setup():
        B, S, D = 1, 2048, 512
        P = D
        Lambda_re = -0.5 * (lambda _x: torch.exp(torch.as_tensor(_x)))((lambda *s: torch.randn(*s, dtype=torch.bfloat16) * 0.8)(P))
        Lambda_im = (lambda *s: torch.randn(*s, dtype=torch.bfloat16) * 0.8)(P) * 1.0
        B_re = (lambda *s: torch.randn(*s, dtype=torch.bfloat16) * 0.8)(P, D) * (D ** -0.5)
        B_im = (lambda *s: torch.randn(*s, dtype=torch.bfloat16) * 0.8)(P, D) * (D ** -0.5)
        C_re = (lambda *s: torch.randn(*s, dtype=torch.bfloat16) * 0.8)(D, P) * (P ** -0.5)
        C_im = (lambda *s: torch.randn(*s, dtype=torch.bfloat16) * 0.8)(D, P) * (P ** -0.5)
        log_dt = (lambda *s: torch.randn(*s, dtype=torch.bfloat16) * 0.8)(P) * 0.3 - 2.0
        Dskip = (lambda *s: torch.randn(*s, dtype=torch.bfloat16) * 0.8)(D)
        return {
            "x": _w((lambda *s: torch.randn(*s, dtype=torch.bfloat16) * 0.05)(B, S, D)),
            "Lambda_re": _w(Lambda_re),
            "Lambda_im": _w(Lambda_im),
            "B_re": _w(B_re),
            "B_im": _w(B_im),
            "C_re": _w(C_re),
            "C_im": _w(C_im),
            "log_dt": _w(log_dt),
            "Dskip": _w(Dskip),
        }
    _A_in = _A_setup()

    def _B_setup():
        B, S, D, F = 1, 2048, 512, 1792
        return {
            "x": _w((lambda *s: torch.randn(*s, dtype=torch.bfloat16) * 0.05)(B, S, D)),
            "w_gate": _w((lambda *s: torch.randn(*s, dtype=torch.bfloat16) * 0.05)(D, F)),
            "w_up": _w((lambda *s: torch.randn(*s, dtype=torch.bfloat16) * 0.05)(D, F)),
            "w_down": _w((lambda *s: torch.randn(*s, dtype=torch.bfloat16) * 0.05)(F, D)),
        }
    _B_in = _B_setup()

    return {
        "A_x": _A_in["x"],
        "A_Lambda_re": _A_in["Lambda_re"],
        "A_Lambda_im": _A_in["Lambda_im"],
        "A_B_re": _A_in["B_re"],
        "A_B_im": _A_in["B_im"],
        "A_C_re": _A_in["C_re"],
        "A_C_im": _A_in["C_im"],
        "A_log_dt": _A_in["log_dt"],
        "A_Dskip": _A_in["Dskip"],
        "B_x": _B_in["x"],
        "B_w_gate": _B_in["w_gate"],
        "B_w_up": _B_in["w_up"],
        "B_w_down": _B_in["w_down"],
    }

def reference(A_x, A_Lambda_re, A_Lambda_im, A_B_re, A_B_im, A_C_re, A_C_im, A_log_dt, A_Dskip, B_x, B_w_gate, B_w_up, B_w_down):
    def _A_ref(x, Lambda_re, Lambda_im, B_re, B_im, C_re, C_im, log_dt, Dskip):
        Bsz, L, H = x.shape
        Lam = Lambda_re + 1j * Lambda_im
        Bmat = B_re + 1j * B_im
        Cmat = C_re + 1j * C_im
        dt = torch.exp(log_dt)
        Lam_bar = torch.exp(dt * Lam)
        B_bar = ((Lam_bar - 1.0) / Lam)[:, None] * Bmat
        Bu = torch.einsum("bld,pd->blp", x + 0j, B_bar)
        h = torch.zeros_like(Bu[:, 0, :])
        hs = []
        for t in range(L):
            h = Lam_bar[None, :] * h + Bu[:, t, :]
            hs.append(h)
        hseq = torch.stack(hs, 1)
        y = 2.0 * torch.einsum("blp,dp->bld", hseq, Cmat).real + x * Dskip[None, None, :]
        return y

    def _B_ref(x, w_gate, w_up, w_down):
        g = torch.einsum("bsd,df->bsf", x, w_gate)
        u = torch.einsum("bsd,df->bsf", x, w_up)
        h = _sigmoid(g) * u
        return torch.einsum("bsf,fd->bsd", h, w_down)

    x = A_x
    xn = _layernorm(x, axis=-1)
    return x + _A_ref(xn, A_Lambda_re, A_Lambda_im, A_B_re, A_B_im, A_C_re, A_C_im, A_log_dt, A_Dskip) + _B_ref(xn, B_w_gate, B_w_up, B_w_down)
```

```asm
; @launch grid=(256,1,1) block=(256,1,1) lds=163840
.amdgcn_target "amdgcn-amd-amdhsa--gfx950"
.text
.globl parallel_sum__ssm_conv_s5__glu_gated_glu__prompt_kernel
.p2align 8
.type parallel_sum__ssm_conv_s5__glu_gated_glu__prompt_kernel,@function
parallel_sum__ssm_conv_s5__glu_gated_glu__prompt_kernel:
  s_cmp_ge_u32 s2, 256
  s_cbranch_scc1 L_end
  s_load_dwordx16 s[64:79], s[0:1], 0
  s_load_dwordx16 s[80:95], s[0:1], 64
  s_memrealtime s[100:101]
  v_lshrrev_b32 v136, 6, v0
  v_and_b32 v101, 63, v0
  v_readfirstlane_b32 s48, v136
  v_lshrrev_b32 v102, 3, v101
  v_and_b32 v103, 7, v101
  v_lshlrev_b32 v1, 4, v101
  s_and_b32 s54, s2, 7
  s_lshr_b32 s55, s2, 3
  s_getpc_b64 s[4:5]
L_pc:
  s_sub_u32 s4, s4, L_pc-parallel_sum__ssm_conv_s5__glu_gated_glu__prompt_kernel
  s_subb_u32 s5, s5, 0
  s_lshl_b32 s57, s55, 2
  s_add_u32 s57, s57, s48
  s_lshl_b32 s57, s57, 8
  v_lshl_add_u32 v145, v101, 2, s57
  v_min_u32 v145, L_codeend-parallel_sum__ssm_conv_s5__glu_gated_glu__prompt_kernel-8, v145
  global_load_dword v82, v145, s[4:5]
  s_lshr_b32 s49, s54, 2
  s_lshl_b32 s49, s49, 3
  s_lshr_b32 s56, s55, 2
  s_add_u32 s49, s49, s56
  s_and_b32 s50, s54, 3
  s_lshl_b32 s50, s50, 2
  s_and_b32 s56, s55, 3
  s_add_u32 s50, s50, s56
  v_lshrrev_b32 v137, 2, v102
  v_and_b32 v138, 3, v102
  v_lshl_add_u32 v137, v137, 4, v138
  v_lshlrev_b32 v137, 10, v137
  v_lshrrev_b32 v138, 1, v102
  v_xor_b32 v138, v138, v103
  v_lshl_add_u32 v7, v138, 4, v137
  v_xor_b32 v8, 64, v7
  v_add_u32 v9, 6144, v7
  v_add_u32 v8, 3072, v8
  v_add_u32 v10, 6144, v8
  s_lshl_b32 s53, s49, 17
  s_lshl_b32 s57, s48, 15
  s_add_u32 s53, s53, s57
  s_mul_i32 s61, s48, 22528
  s_add_u32 s61, s61, 65536
  s_lshl_b32 s60, s48, 14
  s_lshr_b32 s96, s50, 2
  s_lshl_b32 s96, s96, 1
  s_add_u32 s96, s96, s49
  s_and_b32 s96, s96, 7
  s_lshl_b32 s96, s96, 7
  s_add_u32 s98, s53, s96
  s_waitcnt lgkmcnt(0)
  s_mov_b32 s4, s64
  s_mov_b32 s5, s65
  s_mov_b32 s6, 2097152
  s_mov_b32 s7, 0x20000
  s_mov_b32 s8, s84
  s_mov_b32 s9, s85
  s_add_u32 m0, s61, 0
  s_nop 0
  buffer_load_dwordx4 v7, s[4:7], s98 offen offset:0 lds
  s_mov_b32 s10, 1835008
  s_mov_b32 s11, 0x20000
  s_sub_u32 s12, s86, 2048
  s_subb_u32 s13, s87, 0
  buffer_load_dwordx4 v8, s[4:7], s98 offen offset:1024 lds
  s_mov_b32 s14, 1837056
  s_mov_b32 s15, 0x20000
  v_and_b32 v147, 2, v102
  v_xor_b32 v147, v147, v103
  buffer_load_dwordx4 v9, s[4:7], s98 offen offset:2048 lds
  v_mul_u32_u24 v148, 3584, v102
  v_lshl_add_u32 v2, v147, 4, v148
  v_add_u32 v3, 27648, v2
  v_xor_b32 v4, 64, v2
  v_add_u32 v5, 27648, v4
  s_mul_i32 s58, s48, 57344
  s_lshl_b32 s57, s50, 7
  buffer_load_dwordx4 v10, s[4:7], s98 offen offset:3072 lds
  s_add_u32 s98, s98, 128
  s_and_b32 s98, s98, 0xfffffbff
  s_add_u32 s58, s58, s57
  s_lshl_b32 s97, s48, 12
  s_add_u32 s83, s58, 1835008
  s_mul_i32 s82, s96, 1792
  s_add_u32 m0, s97, 0
  s_add_u32 s82, s82, s58
  buffer_load_dwordx4 v2, s[8:11], s82 offen offset:0 lds
  buffer_load_dwordx4 v3, s[8:11], s82 offen offset:1024 lds
  buffer_load_dwordx4 v4, s[12:15], s82 offen offset:2048 lds
  s_mov_b32 s3, s100
  buffer_load_dwordx4 v5, s[12:15], s82 offen offset:3072 lds
  s_add_u32 s82, s82, 229376
  s_cmp_eq_u32 s82, s83
  s_cselect_b32 s82, s58, s82
  s_and_b32 s57, s48, 1
  s_lshl_b32 s57, s57, 2
  v_xor_b32 v138, s57, v138
  v_lshlrev_b32 v137, 10, v102
  v_lshl_add_u32 v6, v138, 4, v137
  s_lshl_b32 s59, s50, 15
  s_lshl_b32 s57, s48, 13
  s_add_u32 s59, s59, s57
  s_add_u32 s99, s59, s96
  s_lshl_b32 s56, s49, 7
  s_and_b32 s57, s50, 2
  s_lshl_b32 s57, s57, 5
  s_add_u32 s56, s56, s57
  s_and_b32 s57, s50, 12
  s_lshl_b32 s57, s57, 2
  s_add_u32 s56, s56, s57
  s_and_b32 s57, s50, 1
  s_lshl_b32 s57, s57, 3
  s_add_u32 s56, s56, s57
  s_lshl_b32 s57, s48, 1
  s_add_u32 s56, s56, s57
  v_and_b32 v141, 31, v101
  s_lshl_b32 s57, s50, 5
  v_add_lshl_u32 v141, v141, s57, 1
  v_lshrrev_b32 v139, 5, v101
  v_lshl_add_u32 v140, v139, 9, v1
  s_lshl_b32 s57, s56, 10
  buffer_load_dwordx4 v[84:87], v140, s[4:7], s57 offen
  buffer_load_dwordx4 v[88:91], v140, s[4:7], s57 offen offset:512
  global_load_ushort v142, v141, s[66:67]
  global_load_ushort v143, v141, s[68:69]
  global_load_ushort v144, v141, s[78:79]
  s_mov_b32 s44, s92
  s_mov_b32 s45, s93
  s_mov_b32 s46, 256
  s_mov_b32 s47, 0x20000
  v_mov_b32 v145, 2146435072
  v_cmp_eq_u32 vcc, 0, v101
  s_or_b32 s57, s2, s48
  s_cmp_eq_u32 s57, 0
  s_cselect_b32 s57, 0, 2146435072
  v_cndmask_b32 v13, v145, v101, vcc
  s_or_b32 s3, s3, 1
  v_mov_b32 v145, s3
  buffer_store_dword v145, v13, s[44:47], s57 offen sc1
  s_mov_b32 s16, s70
  s_mov_b32 s17, s71
  s_mov_b32 s18, 524288
  s_mov_b32 s19, 0x20000
  s_sub_u32 s20, s72, 1024
  s_subb_u32 s21, s73, 0
  s_mov_b32 s22, 525312
  s_mov_b32 s23, 0x20000
  v_and_b32 v146, 31, v101
  v_bfe_u32 v147, v146, 1, 3
  v_xor_b32 v147, v147, v139
  s_lshl_b32 s57, s48, 1
  s_add_u32 m0, s61, 4096
  v_xor_b32 v147, s57, v147
  buffer_load_dwordx4 v7, s[4:7], s98 offen offset:0 lds
  v_lshlrev_b32 v147, 4, v147
  v_lshl_add_u32 v148, v146, 7, s61
  v_add_u32 v34, v148, v147
  v_xor_b32 v35, 32, v34
  v_xor_b32 v36, 64, v34
  v_xor_b32 v37, 96, v34
  v_lshrrev_b32 v148, 3, v146
  v_mul_u32_u24 v148, 22528, v148
  v_and_b32 v149, 7, v146
  v_lshl_add_u32 v148, v149, 7, v148
  v_add_u32 v148, 77824, v148
  buffer_load_dwordx4 v8, s[4:7], s98 offen offset:1024 lds
  v_add_u32 v30, v148, v147
  v_xor_b32 v31, 32, v30
  v_xor_b32 v32, 64, v30
  v_xor_b32 v33, 96, v30
  s_mov_b32 s63, 0x3f803f80
  v_and_b32 v148, 15, v101
  v_bfe_u32 v149, v101, 4, 1
  v_mov_b32 v150, s63
  v_mov_b32 v151, 0
  v_cmp_eq_u32 vcc, v148, v149
  s_nop 1
  v_cndmask_b32 v104, v151, v150, vcc
  buffer_load_dwordx4 v9, s[4:7], s98 offen offset:2048 lds
  v_mov_b32 v105, v104
  v_mov_b32 v106, v104
  v_mov_b32 v107, v104
  v_lshrrev_b32 v157, 4, v101
  v_bfe_u32 v158, v101, 2, 2
  v_and_b32 v159, 3, v101
  v_and_b32 v147, 1, v157
  v_lshlrev_b32 v148, 11, v147
  v_lshl_add_u32 v148, v139, 10, v148
  v_lshl_add_u32 v148, v158, 7, v148
  v_lshrrev_b32 v149, 1, v159
  v_lshl_add_u32 v148, v149, 3, v148
  v_add_u32 v148, s97, v148
  v_lshlrev_b32 v147, 2, v147
  v_and_b32 v149, 2, v158
  v_or_b32 v147, v147, v149
  v_and_b32 v149, 1, v159
  buffer_load_dwordx4 v10, s[4:7], s98 offen offset:3072 lds
  s_add_u32 s98, s98, 128
  s_and_b32 s98, s98, 0xfffffbff
  v_or_b32 v147, v147, v149
  v_lshl_add_u32 v14, v147, 4, v148
  v_xor_b32 v15, 4096, v14
  v_xor_b32 v16, 8192, v14
  v_xor_b32 v17, 12288, v14
  v_xor_b32 v18, 32, v14
  v_xor_b32 v19, 4128, v14
  v_xor_b32 v20, 8224, v14
  v_xor_b32 v21, 12320, v14
  v_xor_b32 v22, 64, v14
  v_xor_b32 v23, 4160, v14
  v_xor_b32 v24, 8256, v14
  v_xor_b32 v25, 12352, v14
  v_xor_b32 v26, 96, v14
  v_xor_b32 v27, 4192, v14
  v_xor_b32 v28, 8288, v14
  v_xor_b32 v29, 12384, v14
  s_mov_b32 s24, s94
  s_add_u32 m0, s97, 16384
  s_nop 0
  buffer_load_dwordx4 v2, s[8:11], s82 offen offset:0 lds
  s_mov_b32 s25, s95
  s_mov_b32 s26, 23068672
  s_mov_b32 s27, 0x20000
  s_lshr_b32 s51, s54, 1
  s_lshl_b32 s51, s51, 2
  s_and_b32 s57, s55, 3
  s_add_u32 s51, s51, s57
  s_lshl_b32 s51, s51, 1
  s_and_b32 s57, s54, 1
  s_add_u32 s51, s51, s57
  s_lshr_b32 s52, s55, 2
  buffer_load_dwordx4 v3, s[8:11], s82 offen offset:1024 lds
  v_and_b32 v150, 15, v101
  s_lshl_b32 s57, s52, 4
  v_add_lshl_u32 v150, v150, s57, 3
  global_load_dwordx2 v[108:109], v150, s[80:81]
  s_and_b32 s55, s55, 3
  s_lshl_b32 s55, s55, 1
  s_xor_b32 s55, s55, s52
  s_bitcmp1_b32 s55, 0
  s_cselect_b32 s28, s76, s74
  s_cselect_b32 s29, s77, s75
  s_cselect_b32 s32, s74, s76
  s_cselect_b32 s33, s75, s77
  buffer_load_dwordx4 v4, s[12:15], s82 offen offset:2048 lds
  s_mov_b32 s30, 524288
  s_mov_b32 s31, 0x20000
  s_mov_b32 s34, 524288
  s_mov_b32 s35, 0x20000
  s_mov_b32 s36, s88
  s_mov_b32 s37, s89
  s_mov_b32 s38, 1835008
  s_mov_b32 s39, 0x20000
  s_mov_b32 s40, s90
  s_mov_b32 s41, s91
  s_mov_b32 s42, 4194304
  s_mov_b32 s43, 0x20000
  s_lshl_b32 s62, s49, 2
  s_add_u32 s62, s62, s48
  s_lshl_b32 s62, s62, 4
  s_add_u32 s62, s62, s50
  s_lshl_b32 s62, s62, 14
  s_add_u32 s62, s62, 1048576
  s_lshl_b32 s70, s2, 2
  s_add_u32 s70, s70, s48
  v_lshlrev_b32 v118, 3, v1
  buffer_load_dwordx4 v5, s[12:15], s82 offen offset:3072 lds
  s_add_u32 s82, s82, 229376
  s_cmp_eq_u32 s82, s83
  s_cselect_b32 s82, s58, s82
  v_mov_b32 v119, 2146435072
  v_cmp_gt_u32 vcc, 64, v1
  s_nop 1
  v_cndmask_b32 v112, v119, v118, vcc
  v_cmp_gt_u32 vcc, 96, v1
  s_nop 1
  v_cndmask_b32 v113, v119, v118, vcc
  v_cmp_gt_u32 vcc, 128, v1
  s_nop 1
  v_cndmask_b32 v114, v119, v118, vcc
  v_cmp_gt_u32 vcc, 224, v1
  s_nop 1
  v_cndmask_b32 v115, v119, v118, vcc
  v_cmp_gt_u32 vcc, 256, v1
  s_nop 1
  v_cndmask_b32 v116, v119, v118, vcc
  v_lshrrev_b32 v52, 1, v1
  s_lshl_b32 s68, s48, 9
  s_add_u32 s68, s68, 155648
  v_add_u32 v52, s68, v52
  v_mov_b32 v61, 0
  v_mov_b32 v62, 0
  v_mov_b32 v63, 0
  v_mov_b32 v65, 0
  v_mov_b32 v66, 0
  v_mov_b32 v67, 0
  v_mov_b32 v69, 0
  v_mov_b32 v70, 0
  v_mov_b32 v71, 0
  ds_write_b64 v52, v[62:63]
  v_lshlrev_b32 v53, 3, v146
  v_add_u32 v53, 155648, v53
  v_lshlrev_b32 v54, 2, v103
  v_lshlrev_b32 v111, 4, v146
  v_add_u32 v111, 155648, v111
  s_lshl_b32 s68, s48, 2
  v_add_u32 v150, s68, v111
  v_mov_b32 v151, 0x30000
  v_cmp_gt_u32 vcc, 16, v101
  s_nop 1
  v_cndmask_b32 v110, v151, v150, vcc
  s_waitcnt vmcnt(15) lgkmcnt(0)
  s_barrier
  ds_read_b128 a[0:3], v34 offset:0
  ds_read_b64_tr_b16 a[128:129], v14 offset:0
  ds_read_b64_tr_b16 a[130:131], v14 offset:512
  ds_read_b64_tr_b16 a[132:133], v18 offset:0
  ds_read_b64_tr_b16 a[134:135], v18 offset:512
  ds_read_b64_tr_b16 a[136:137], v22 offset:0
  ds_read_b64_tr_b16 a[138:139], v22 offset:512
  ds_read_b64_tr_b16 a[140:141], v26 offset:0
  ds_read_b64_tr_b16 a[142:143], v26 offset:512
  ds_read_b128 a[4:7], v35 offset:0
  ds_read_b64_tr_b16 a[144:145], v15 offset:0
  ds_read_b64_tr_b16 a[146:147], v15 offset:512
  ds_read_b64_tr_b16 a[148:149], v19 offset:0
  ds_read_b64_tr_b16 a[150:151], v19 offset:512
  ds_read_b64_tr_b16 a[152:153], v23 offset:0
  s_waitcnt lgkmcnt(14)
  ds_read_b64_tr_b16 a[154:155], v23 offset:512
  s_waitcnt lgkmcnt(14)
  ds_read_b64_tr_b16 a[156:157], v27 offset:0
  s_waitcnt lgkmcnt(14)
  ds_read_b64_tr_b16 a[158:159], v27 offset:512
  v_mfma_f32_32x32x16_bf16 v[160:175], a[128:131], a[0:3], 0
  s_add_u32 m0, s61, 8192
  s_nop 0
  buffer_load_dwordx4 v7, s[4:7], s98 offen offset:0 lds
  s_waitcnt vmcnt(15)
  v_dot2_f32_bf16 v152, v84, s63, 0
  v_dot2_f32_bf16 v153, v84, v84, 0
  v_dot2_f32_bf16 v152, v85, s63, v152
  v_mfma_f32_16x16x32_bf16 a[176:179], v[104:107], a[128:131], 0
  s_waitcnt lgkmcnt(14)
  ds_read_b128 a[8:11], v36 offset:0
  s_waitcnt lgkmcnt(14)
  ds_read_b64_tr_b16 a[128:129], v16 offset:0
  s_waitcnt lgkmcnt(14)
  ds_read_b64_tr_b16 a[130:131], v16 offset:512
  v_mfma_f32_32x32x16_bf16 v[176:191], a[132:135], a[0:3], 0
  buffer_load_dwordx4 v8, s[4:7], s98 offen offset:1024 lds
  v_dot2_f32_bf16 v153, v85, v85, v153
  v_dot2_f32_bf16 v152, v86, s63, v152
  v_dot2_f32_bf16 v153, v86, v86, v153
  v_mfma_f32_16x16x32_bf16 a[180:183], v[104:107], a[132:135], 0
  s_waitcnt lgkmcnt(9)
  ds_read_b64_tr_b16 a[132:133], v20 offset:0
  ds_read_b64_tr_b16 a[134:135], v20 offset:512
  v_mfma_f32_32x32x16_bf16 v[192:207], a[136:139], a[0:3], 0
  buffer_load_dwordx4 v9, s[4:7], s98 offen offset:2048 lds
  v_dot2_f32_bf16 v152, v87, s63, v152
  v_dot2_f32_bf16 v153, v87, v87, v153
  s_waitcnt vmcnt(16)
  v_dot2_f32_bf16 v152, v88, s63, v152
  v_dot2_f32_bf16 v153, v88, v88, v153
  v_mfma_f32_16x16x32_bf16 a[184:187], v[104:107], a[136:139], 0
  ds_read_b64_tr_b16 a[136:137], v24 offset:0
  ds_read_b64_tr_b16 a[138:139], v24 offset:512
  v_mfma_f32_32x32x16_bf16 v[208:223], a[140:143], a[0:3], 0
  buffer_load_dwordx4 v10, s[4:7], s98 offen offset:3072 lds
  s_add_u32 s98, s98, 128
  s_and_b32 s98, s98, 0xfffffbff
  v_mfma_f32_16x16x32_bf16 a[188:191], v[104:107], a[140:143], 0
  ds_read_b64_tr_b16 a[140:141], v28 offset:0
  ds_read_b64_tr_b16 a[142:143], v28 offset:512
  v_mfma_f32_32x32x16_bf16 v[160:175], a[144:147], a[4:7], v[160:175]
  s_waitcnt lgkmcnt(5)
  ds_read_b128 a[12:15], v37 offset:0
  ds_read_b64_tr_b16 a[144:145], v17 offset:0
  ds_read_b64_tr_b16 a[146:147], v17 offset:512
  buffer_load_dword v51, off, s[44:47], 0 sc1
  v_dot2_f32_bf16 v152, v89, s63, v152
  v_mfma_f32_32x32x16_bf16 v[176:191], a[148:151], a[4:7], v[176:191]
  ds_read_b64_tr_b16 a[148:149], v21 offset:0
  s_add_u32 m0, s97, 32768
  ds_read_b64_tr_b16 a[150:151], v21 offset:512
  buffer_load_dwordx4 v2, s[8:11], s82 offen offset:0 lds
  v_dot2_f32_bf16 v153, v89, v89, v153
  v_dot2_f32_bf16 v152, v90, s63, v152
  v_mfma_f32_32x32x16_bf16 v[192:207], a[152:155], a[4:7], v[192:207]
  ds_read_b64_tr_b16 a[152:153], v25 offset:0
  ds_read_b64_tr_b16 a[154:155], v25 offset:512
  buffer_load_dwordx4 v3, s[8:11], s82 offen offset:1024 lds
  v_dot2_f32_bf16 v153, v90, v90, v153
  v_mfma_f32_32x32x16_bf16 v[208:223], a[156:159], a[4:7], v[208:223]
  ds_read_b64_tr_b16 a[156:157], v29 offset:0
  ds_read_b64_tr_b16 a[158:159], v29 offset:512
  buffer_load_dwordx4 v4, s[12:15], s82 offen offset:2048 lds
  v_dot2_f32_bf16 v152, v91, s63, v152
  v_dot2_f32_bf16 v153, v91, v91, v153
  s_nop 1
  v_add_f32_dpp v152, v152, v152 quad_perm:[1,0,3,2] row_mask:0xf bank_mask:0xf
  v_add_f32_dpp v153, v153, v153 quad_perm:[1,0,3,2] row_mask:0xf bank_mask:0xf
  s_nop 0
  v_add_f32_dpp v152, v152, v152 quad_perm:[2,3,0,1] row_mask:0xf bank_mask:0xf
  v_add_f32_dpp v153, v153, v153 quad_perm:[2,3,0,1] row_mask:0xf bank_mask:0xf
  s_waitcnt vmcnt(8)
  s_barrier
  v_mfma_f32_32x32x16_bf16 v[160:175], a[128:131], a[8:11], v[160:175]
  ds_read_b128 a[16:19], v34 offset:4096
  s_waitcnt lgkmcnt(6)
  ds_read_b64_tr_b16 a[128:129], v14 offset:16384
  ds_read_b64_tr_b16 a[130:131], v14 offset:16896
  buffer_load_dwordx4 v5, s[12:15], s82 offen offset:3072 lds
  s_add_u32 s82, s82, 229376
  s_cmp_eq_u32 s82, s83
  s_cselect_b32 s82, s58, s82
  v_mfma_f32_32x32x16_bf16 v[176:191], a[132:135], a[8:11], v[176:191]
  ds_read_b64_tr_b16 a[132:133], v18 offset:16384
  s_add_u32 m0, s61, 12288
  ds_read_b64_tr_b16 a[134:135], v18 offset:16896
  buffer_load_dwordx4 v7, s[4:7], s98 offen offset:0 lds
  v_mfma_f32_32x32x16_bf16 v[192:207], a[136:139], a[8:11], v[192:207]
  ds_read_b64_tr_b16 a[136:137], v22 offset:16384
  ds_read_b64_tr_b16 a[138:139], v22 offset:16896
  buffer_load_dwordx4 v8, s[4:7], s98 offen offset:1024 lds
  v_add_f32_dpp v152, v152, v152 row_half_mirror row_mask:0xf bank_mask:0xf
  v_add_f32_dpp v153, v153, v153 row_half_mirror row_mask:0xf bank_mask:0xf
  s_nop 0
  v_add_f32_dpp v152, v152, v152 row_mirror row_mask:0xf bank_mask:0xf
  v_mfma_f32_32x32x16_bf16 v[208:223], a[140:143], a[8:11], v[208:223]
  ds_read_b64_tr_b16 a[140:141], v26 offset:16384
  ds_read_b64_tr_b16 a[142:143], v26 offset:16896
  buffer_load_dwordx4 v9, s[4:7], s98 offen offset:2048 lds
  v_add_f32_dpp v153, v153, v153 row_mirror row_mask:0xf bank_mask:0xf
  v_mov_b32 v155, v152
  v_mov_b32 v156, v153
  s_nop 0
  v_permlane16_swap_b32 v155, v152
  v_permlane16_swap_b32 v156, v153
  v_add_f32 v152, v152, v155
  v_add_f32 v153, v153, v156
  v_mfma_f32_32x32x16_bf16 v[160:175], a[144:147], a[12:15], v[160:175]
  ds_read_b128 a[20:23], v35 offset:4096
  s_waitcnt lgkmcnt(6)
  ds_read_b64_tr_b16 a[144:145], v15 offset:16384
  ds_read_b64_tr_b16 a[146:147], v15 offset:16896
  buffer_load_dwordx4 v10, s[4:7], s98 offen offset:3072 lds
  s_add_u32 s98, s98, 128
  s_and_b32 s98, s98, 0xfffffbff
  v_mfma_f32_32x32x16_bf16 v[176:191], a[148:151], a[12:15], v[176:191]
  ds_read_b64_tr_b16 a[148:149], v19 offset:16384
  s_add_u32 m0, s97, 49152
  ds_read_b64_tr_b16 a[150:151], v19 offset:16896
  buffer_load_dwordx4 v2, s[8:11], s82 offen offset:0 lds
  v_mul_f32 v152, 0x3b000000, v152
  v_mfma_f32_32x32x16_bf16 v[192:207], a[152:155], a[12:15], v[192:207]
  ds_read_b64_tr_b16 a[152:153], v23 offset:16384
  ds_read_b64_tr_b16 a[154:155], v23 offset:16896
  buffer_load_dwordx4 v3, s[8:11], s82 offen offset:1024 lds
  v_mul_f32 v153, 0x3b000000, v153
  v_mfma_f32_32x32x16_bf16 v[208:223], a[156:159], a[12:15], v[208:223]
  ds_read_b64_tr_b16 a[156:157], v27 offset:16384
  ds_read_b64_tr_b16 a[158:159], v27 offset:16896
  buffer_load_dwordx4 v4, s[12:15], s82 offen offset:2048 lds
  v_fma_f32 v153, -v152, v152, v153
  v_max_f32 v153, 0, v153
  v_cvt_pk_bf16_f32 v154, v152, v153
  v_lshlrev_b32 v92, 16, v154
  v_and_b32 v153, 0xffff0000, v154
  v_add_f32 v153, 0x3727c5ac, v153
  v_cvt_pk_bf16_f32 v154, v153, v153
  v_lshlrev_b32 v153, 16, v154
  v_mfma_f32_32x32x16_bf16 v[160:175], a[128:131], a[16:19], v[160:175]
  buffer_load_dwordx4 v5, s[12:15], s82 offen offset:3072 lds
  s_add_u32 s82, s82, 229376
  s_cmp_eq_u32 s82, s83
  s_cselect_b32 s82, s58, s82
  v_mfma_f32_16x16x32_bf16 a[176:179], v[104:107], a[128:131], a[176:179]
  ds_read_b128 a[24:27], v36 offset:4096
  s_waitcnt lgkmcnt(3)
  ds_read_b64_tr_b16 a[128:129], v16 offset:16384
  ds_read_b64_tr_b16 a[130:131], v16 offset:16896
  v_mfma_f32_32x32x16_bf16 v[176:191], a[132:135], a[16:19], v[176:191]
  s_add_u32 m0, s61, 16384
  s_nop 0
  buffer_load_dwordx4 v7, s[4:7], s98 offen offset:0 lds
  v_sqrt_f32 v153, v153
  s_nop 0
  v_cvt_pk_bf16_f32 v154, v153, v153
  v_lshlrev_b32 v94, 16, v154
  v_lshlrev_b32 v155, 4, v139
  v_mfma_f32_16x16x32_bf16 a[180:183], v[104:107], a[132:135], a[180:183]
  ds_read_b64_tr_b16 a[132:133], v20 offset:16384
  ds_read_b64_tr_b16 a[134:135], v20 offset:16896
  v_mfma_f32_32x32x16_bf16 v[192:207], a[136:139], a[16:19], v[192:207]
  buffer_load_dwordx4 v8, s[4:7], s98 offen offset:1024 lds
  v_mov_b32 v156, 2146435072
  v_cmp_eq_u32 vcc, 0, v146
  s_nop 1
  v_cndmask_b32 v155, v156, v155, vcc
  v_mfma_f32_16x16x32_bf16 a[184:187], v[104:107], a[136:139], a[184:187]
  ds_read_b64_tr_b16 a[136:137], v24 offset:16384
  ds_read_b64_tr_b16 a[138:139], v24 offset:16896
  v_mfma_f32_32x32x16_bf16 v[208:223], a[140:143], a[16:19], v[208:223]
  buffer_load_dwordx4 v9, s[4:7], s98 offen offset:2048 lds
  v_mfma_f32_16x16x32_bf16 a[188:191], v[104:107], a[140:143], a[188:191]
  ds_read_b64_tr_b16 a[140:141], v28 offset:16384
  ds_read_b64_tr_b16 a[142:143], v28 offset:16896
  v_mfma_f32_32x32x16_bf16 v[160:175], a[144:147], a[20:23], v[160:175]
  ds_read_b128 a[28:31], v37 offset:4096
  ds_read_b64_tr_b16 a[144:145], v17 offset:16384
  ds_read_b64_tr_b16 a[146:147], v17 offset:16896
  buffer_load_dwordx4 v10, s[4:7], s98 offen offset:3072 lds
  s_add_u32 s98, s98, 128
  s_and_b32 s98, s98, 0xfffffbff
  v_mfma_f32_32x32x16_bf16 v[176:191], a[148:151], a[20:23], v[176:191]
  ds_read_b64_tr_b16 a[148:149], v21 offset:16384
  s_waitcnt lgkmcnt(8)
  ds_read_b64_tr_b16 a[150:151], v21 offset:16896
  v_and_b32 v147, 2, v102
  v_lshlrev_b32 v147, 1, v147
  v_xor_b32 v147, v147, v103
  v_lshlrev_b32 v148, 10, v102
  v_lshl_add_u32 v11, v147, 4, v148
  v_add_u32 v12, 7168, v11
  v_lshl_add_u32 v148, v139, 3, v158
  v_lshlrev_b32 v148, 7, v148
  v_mfma_f32_32x32x16_bf16 v[192:207], a[152:155], a[20:23], v[192:207]
  ds_read_b64_tr_b16 a[152:153], v25 offset:16384
  s_add_u32 m0, s61, 0
  ds_read_b64_tr_b16 a[154:155], v25 offset:16896
  buffer_load_dwordx4 v7, s[4:7], s98 offen offset:0 lds
  s_waitcnt vmcnt(17)
  v_cmp_eq_u32 vcc, 0, v51
  s_and_b64 vcc, exec, vcc
  s_cbranch_vccz L_ok1
  s_mov_b32 s71, 30000
L_sp1:
  s_sleep 1
  buffer_load_dword v51, off, s[44:47], 0 sc1
  s_waitcnt vmcnt(0)
  v_cmp_eq_u32 vcc, 0, v51
  s_and_b64 vcc, exec, vcc
  s_cbranch_vccz L_ok1
  s_sub_u32 s71, s71, 1
  s_cmp_lg_u32 s71, 0
  s_cbranch_scc1 L_sp1
L_ok1:
  v_mov_b32 v93, v51
  v_mov_b32 v95, v51
  v_mfma_f32_32x32x16_bf16 v[208:223], a[156:159], a[20:23], v[208:223]
  ds_read_b64_tr_b16 a[156:157], v29 offset:16384
  ds_read_b64_tr_b16 a[158:159], v29 offset:16896
  s_lshl_b32 s56, s56, 4
  s_add_u32 s56, s56, 262144
  buffer_store_dwordx4 v[92:95], v155, s[24:27], s56 offen sc1
  s_waitcnt vmcnt(14)
  s_barrier
  v_mfma_f32_32x32x16_bf16 v[160:175], a[128:131], a[24:27], v[160:175]
  ds_read_b128 a[32:35], v34 offset:8192
  ds_read_b64_tr_b16 a[128:129], v14 offset:32768
  s_waitcnt lgkmcnt(6)
  ds_read_b64_tr_b16 a[130:131], v14 offset:33280
  buffer_load_dwordx4 v8, s[4:7], s98 offen offset:1024 lds
  v_mfma_f32_32x32x16_bf16 v[176:191], a[132:135], a[24:27], v[176:191]
  ds_read_b64_tr_b16 a[132:133], v18 offset:32768
  ds_read_b64_tr_b16 a[134:135], v18 offset:33280
  buffer_load_dwordx4 v9, s[4:7], s98 offen offset:2048 lds
  v_mfma_f32_32x32x16_bf16 v[192:207], a[136:139], a[24:27], v[192:207]
  ds_read_b64_tr_b16 a[136:137], v22 offset:32768
  ds_read_b64_tr_b16 a[138:139], v22 offset:33280
  buffer_load_dwordx4 v10, s[4:7], s98 offen offset:3072 lds
  s_add_u32 s98, s98, 128
  s_and_b32 s98, s98, 0xfffffbff
  v_mfma_f32_32x32x16_bf16 v[208:223], a[140:143], a[24:27], v[208:223]
  ds_read_b64_tr_b16 a[140:141], v26 offset:32768
  ds_read_b64_tr_b16 a[142:143], v26 offset:33280
  v_and_b32 v147, 1, v157
  v_lshrrev_b32 v149, 1, v159
  v_lshl_add_u32 v147, v147, 1, v149
  v_and_b32 v149, 2, v158
  v_lshlrev_b32 v149, 1, v149
  v_xor_b32 v147, v147, v149
  v_lshl_add_u32 v148, v147, 4, v148
  v_mfma_f32_32x32x16_bf16 v[160:175], a[144:147], a[28:31], v[160:175]
  ds_read_b128 a[36:39], v35 offset:8192
  ds_read_b64_tr_b16 a[144:145], v15 offset:32768
  s_add_u32 m0, s97, 0
  s_waitcnt lgkmcnt(6)
  ds_read_b64_tr_b16 a[146:147], v15 offset:33280
  buffer_load_dwordx4 v2, s[8:11], s82 offen offset:0 lds
  v_mfma_f32_32x32x16_bf16 v[176:191], a[148:151], a[28:31], v[176:191]
  ds_read_b64_tr_b16 a[148:149], v19 offset:32768
  ds_read_b64_tr_b16 a[150:151], v19 offset:33280
  buffer_load_dwordx4 v3, s[8:11], s82 offen offset:1024 lds
  v_mfma_f32_32x32x16_bf16 v[192:207], a[152:155], a[28:31], v[192:207]
  ds_read_b64_tr_b16 a[152:153], v23 offset:32768
  ds_read_b64_tr_b16 a[154:155], v23 offset:33280
  buffer_load_dwordx4 v4, s[12:15], s82 offen offset:2048 lds
  v_and_b32 v149, 1, v159
  v_lshl_add_u32 v148, v149, 3, v148
  v_mfma_f32_32x32x16_bf16 v[208:223], a[156:159], a[28:31], v[208:223]
  ds_read_b64_tr_b16 a[156:157], v27 offset:32768
  ds_read_b64_tr_b16 a[158:159], v27 offset:33280
  buffer_load_dwordx4 v5, s[12:15], s82 offen offset:3072 lds
  s_add_u32 s82, s82, 229376
  s_cmp_eq_u32 s82, s83
  s_cselect_b32 s82, s58, s82
  v_add_u32 v57, s61, v148
  v_xor_b32 v58, 64, v57
  v_bfe_u32 v147, v101, 2, 1
  v_bfe_u32 v148, v101, 3, 2
  v_lshlrev_b32 v147, 4, v147
  v_mfma_f32_32x32x16_bf16 v[160:175], a[128:131], a[32:35], v[160:175]
  s_add_u32 m0, s61, 4096
  s_nop 0
  buffer_load_dwordx4 v7, s[4:7], s98 offen offset:0 lds
  v_lshl_add_u32 v147, v148, 2, v147
  v_add_u32 v147, v147, v159
  v_mfma_f32_16x16x32_bf16 a[176:179], v[104:107], a[128:131], a[176:179]
  ds_read_b128 a[40:43], v36 offset:8192
  ds_read_b64_tr_b16 a[128:129], v16 offset:32768
  s_waitcnt lgkmcnt(4)
  ds_read_b64_tr_b16 a[130:131], v16 offset:33280
  v_mfma_f32_32x32x16_bf16 v[176:191], a[132:135], a[32:35], v[176:191]
  buffer_load_dwordx4 v8, s[4:7], s98 offen offset:1024 lds
  v_lshlrev_b32 v100, 4, v147
  v_mfma_f32_16x16x32_bf16 a[180:183], v[104:107], a[132:135], a[180:183]
  ds_read_b64_tr_b16 a[132:133], v20 offset:32768
  ds_read_b64_tr_b16 a[134:135], v20 offset:33280
  s_lshl_b32 s68, s48, 7
  s_add_u32 s68, s68, 163328
  v_mfma_f32_32x32x16_bf16 v[192:207], a[136:139], a[32:35], v[192:207]
  buffer_load_dwordx4 v9, s[4:7], s98 offen offset:2048 lds
  v_lshl_add_u32 v59, v147, 2, s68
  v_lshl_add_u32 v103, v139, 6, s68
  v_mfma_f32_16x16x32_bf16 a[184:187], v[104:107], a[136:139], a[184:187]
  ds_read_b64_tr_b16 a[136:137], v24 offset:32768
  ds_read_b64_tr_b16 a[138:139], v24 offset:33280
  v_mfma_f32_32x32x16_bf16 v[208:223], a[140:143], a[32:35], v[208:223]
  buffer_load_dwordx4 v10, s[4:7], s98 offen offset:3072 lds
  s_add_u32 s98, s98, 128
  s_and_b32 s98, s98, 0xfffffbff
  v_mfma_f32_16x16x32_bf16 a[188:191], v[104:107], a[140:143], a[188:191]
  ds_read_b64_tr_b16 a[140:141], v28 offset:32768
  ds_read_b64_tr_b16 a[142:143], v28 offset:33280
  v_mfma_f32_32x32x16_bf16 v[160:175], a[144:147], a[36:39], v[160:175]
  ds_read_b128 a[44:47], v37 offset:8192
  ds_read_b64_tr_b16 a[144:145], v17 offset:32768
  ds_read_b64_tr_b16 a[146:147], v17 offset:33280
  s_lshl_b32 s69, s49, 11
  s_lshl_b32 s68, s48, 9
  s_add_u32 s69, s69, s68
  s_add_u32 s69, s69, 262144
  s_lshl_b32 s71, s70, 9
  buffer_load_dword v117, v112, s[16:19], s71 offen offset:0
  v_mfma_f32_32x32x16_bf16 v[176:191], a[148:151], a[36:39], v[176:191]
  ds_read_b64_tr_b16 a[148:149], v21 offset:32768
  s_waitcnt lgkmcnt(8)
  ds_read_b64_tr_b16 a[150:151], v21 offset:33280
  s_lshl_b32 s101, s50, 4
  s_add_u32 s101, s101, s49
  s_lshl_b32 s101, s101, 9
  v_mfma_f32_32x32x16_bf16 v[192:207], a[152:155], a[36:39], v[192:207]
  ds_read_b64_tr_b16 a[152:153], v25 offset:32768
  ds_read_b64_tr_b16 a[154:155], v25 offset:33280
  s_add_u32 s101, s101, 65536
  s_lshl_b32 s71, s70, 9
  buffer_load_dword v117, v112, s[20:23], s71 offen offset:1024
  v_mfma_f32_32x32x16_bf16 v[208:223], a[156:159], a[36:39], v[208:223]
  ds_read_b64_tr_b16 a[156:157], v29 offset:32768
  ds_read_b64_tr_b16 a[158:159], v29 offset:33280
  s_waitcnt vmcnt(19)
  s_barrier
  v_mfma_f32_32x32x16_bf16 v[160:175], a[128:131], a[40:43], v[160:175]
  ds_read_b128 a[48:51], v34 offset:12288
  ds_read_b64_tr_b16 a[128:129], v14 offset:49152
  s_waitcnt lgkmcnt(8)
  ds_read_b64_tr_b16 a[130:131], v14 offset:49664
  s_and_b32 s54, s51, 1
  s_lshl_b32 s68, s48, 1
  s_add_u32 s54, s54, s68
  s_lshl_b32 s72, s52, 7
  s_add_u32 m0, s97, 16384
  s_nop 0
  buffer_load_dwordx4 v2, s[8:11], s82 offen offset:0 lds
  v_mfma_f32_32x32x16_bf16 v[176:191], a[132:135], a[40:43], v[176:191]
  ds_read_b64_tr_b16 a[132:133], v18 offset:49152
  ds_read_b64_tr_b16 a[134:135], v18 offset:49664
  s_lshl_b32 s73, s52, 16
  s_lshl_b32 s68, s54, 7
  s_add_u32 s73, s73, s68
  v_mfma_f32_32x32x16_bf16 v[192:207], a[136:139], a[40:43], v[192:207]
  ds_read_b64_tr_b16 a[136:137], v22 offset:49152
  ds_read_b64_tr_b16 a[138:139], v22 offset:49664
  buffer_load_dwordx4 v3, s[8:11], s82 offen offset:1024 lds
  v_mfma_f32_32x32x16_bf16 v[208:223], a[140:143], a[40:43], v[208:223]
  ds_read_b64_tr_b16 a[140:141], v26 offset:49152
  ds_read_b64_tr_b16 a[142:143], v26 offset:49664
  v_mfma_f32_32x32x16_bf16 v[160:175], a[144:147], a[44:47], v[160:175]
  s_waitcnt lgkmcnt(6)
  ds_read_b128 a[52:55], v35 offset:12288
  ds_read_b64_tr_b16 a[144:145], v15 offset:49152
  ds_read_b64_tr_b16 a[146:147], v15 offset:49664
  s_lshl_b32 s64, s51, 19
  s_lshl_b32 s68, s54, 15
  s_add_u32 s64, s64, s68
  s_add_u32 s64, s64, 1048576
  buffer_load_dwordx4 v4, s[12:15], s82 offen offset:2048 lds
  v_mfma_f32_32x32x16_bf16 v[176:191], a[148:151], a[44:47], v[176:191]
  ds_read_b64_tr_b16 a[148:149], v19 offset:49152
  ds_read_b64_tr_b16 a[150:151], v19 offset:49664
  s_lshl_b32 s100, s54, 3
  s_add_u32 s100, s100, s55
  s_lshl_b32 s100, s100, 14
  buffer_load_dwordx4 v5, s[12:15], s82 offen offset:3072 lds
  s_add_u32 s82, s82, 229376
  s_cmp_eq_u32 s82, s83
  s_cselect_b32 s82, s58, s82
  v_mfma_f32_32x32x16_bf16 v[192:207], a[152:155], a[44:47], v[192:207]
  ds_read_b64_tr_b16 a[152:153], v23 offset:49152
  ds_read_b64_tr_b16 a[154:155], v23 offset:49664
  v_mfma_f32_32x32x16_bf16 v[208:223], a[156:159], a[44:47], v[208:223]
  ds_read_b64_tr_b16 a[156:157], v27 offset:49152
  s_add_u32 m0, s61, 8192
  ds_read_b64_tr_b16 a[158:159], v27 offset:49664
  buffer_load_dwordx4 v7, s[4:7], s98 offen offset:0 lds
  v_mfma_f32_32x32x16_bf16 v[160:175], a[128:131], a[48:51], v[160:175]
  s_add_u32 s100, s100, s72
  s_mul_i32 s53, s49, 24
  s_lshr_b32 s68, s50, 1
  s_add_u32 s53, s53, s68
  s_lshl_b32 s53, s53, 5
  s_and_b32 s68, s50, 1
  s_lshl_b32 s68, s68, 2
  v_mfma_f32_16x16x32_bf16 a[176:179], v[104:107], a[128:131], a[176:179]
  s_waitcnt lgkmcnt(4)
  ds_read_b128 a[56:59], v36 offset:12288
  ds_read_b64_tr_b16 a[128:129], v16 offset:49152
  ds_read_b64_tr_b16 a[130:131], v16 offset:49664
  v_mfma_f32_32x32x16_bf16 v[176:191], a[132:135], a[48:51], v[176:191]
  buffer_load_dwordx4 v8, s[4:7], s98 offen offset:1024 lds
  v_mfma_f32_16x16x32_bf16 a[180:183], v[104:107], a[132:135], a[180:183]
  ds_read_b64_tr_b16 a[132:133], v20 offset:49152
  ds_read_b64_tr_b16 a[134:135], v20 offset:49664
  v_mfma_f32_32x32x16_bf16 v[192:207], a[136:139], a[48:51], v[192:207]
  buffer_load_dwordx4 v9, s[4:7], s98 offen offset:2048 lds
  v_mfma_f32_16x16x32_bf16 a[184:187], v[104:107], a[136:139], a[184:187]
  ds_read_b64_tr_b16 a[136:137], v24 offset:49152
  ds_read_b64_tr_b16 a[138:139], v24 offset:49664
  v_mfma_f32_32x32x16_bf16 v[208:223], a[140:143], a[48:51], v[208:223]
  buffer_load_dwordx4 v10, s[4:7], s98 offen offset:3072 lds
  v_mfma_f32_16x16x32_bf16 a[188:191], v[104:107], a[140:143], a[188:191]
  ds_read_b64_tr_b16 a[140:141], v28 offset:49152
  ds_read_b64_tr_b16 a[142:143], v28 offset:49664
  v_mfma_f32_32x32x16_bf16 v[160:175], a[144:147], a[52:55], v[160:175]
  ds_read_b128 a[60:63], v37 offset:12288
  ds_read_b64_tr_b16 a[144:145], v17 offset:49152
  s_waitcnt lgkmcnt(6)
  ds_read_b64_tr_b16 a[146:147], v17 offset:49664
  s_add_u32 s53, s53, s68
  s_add_u32 s53, s53, s48
  s_lshl_b32 s53, s53, 2
  s_lshr_b32 s59, s51, 1
  s_mul_i32 s59, s59, 24
  s_add_u32 s59, s59, s54
  s_lshr_b32 s71, s70, 1
  s_mul_i32 s71, s71, 3584
  s_bitcmp1_b32 s70, 0
  s_cselect_b32 s57, 768, 0
  s_add_u32 s71, s71, s57
  s_add_u32 s71, s71, 2048
  buffer_load_dword v117, v113, s[8:11], s71 offen offset:0
  v_mfma_f32_32x32x16_bf16 v[176:191], a[148:151], a[52:55], v[176:191]
  ds_read_b64_tr_b16 a[148:149], v21 offset:49152
  ds_read_b64_tr_b16 a[150:151], v21 offset:49664
  s_lshl_b32 s59, s59, 7
  v_mfma_f32_32x32x16_bf16 v[192:207], a[152:155], a[52:55], v[192:207]
  ds_read_b64_tr_b16 a[152:153], v25 offset:49152
  ds_read_b64_tr_b16 a[154:155], v25 offset:49664
  s_lshr_b32 s71, s70, 1
  s_mul_i32 s71, s71, 3584
  s_bitcmp1_b32 s70, 0
  s_cselect_b32 s57, 768, 0
  s_add_u32 s71, s71, s57
  s_add_u32 s71, s71, 2048
  buffer_load_dword v117, v113, s[12:15], s71 offen offset:2048
  v_mfma_f32_32x32x16_bf16 v[208:223], a[156:159], a[52:55], v[208:223]
  ds_read_b64_tr_b16 a[156:157], v29 offset:49152
  ds_read_b64_tr_b16 a[158:159], v29 offset:49664
  s_waitcnt vmcnt(16)
  s_barrier
  v_mfma_f32_32x32x16_bf16 v[160:175], a[128:131], a[56:59], v[160:175]
  ds_read_b128 a[64:67], v34 offset:16384
  ds_read_b64_tr_b16 a[128:129], v14 offset:0
  s_add_u32 m0, s97, 32768
  s_waitcnt lgkmcnt(6)
  ds_read_b64_tr_b16 a[130:131], v14 offset:512
  buffer_load_dwordx4 v2, s[8:11], s82 offen offset:0 lds
  v_mfma_f32_32x32x16_bf16 v[176:191], a[132:135], a[56:59], v[176:191]
  ds_read_b64_tr_b16 a[132:133], v18 offset:0
  ds_read_b64_tr_b16 a[134:135], v18 offset:512
  v_lshlrev_b32 v142, 16, v142
  v_lshlrev_b32 v143, 16, v143
  v_lshlrev_b32 v144, 16, v144
  v_mul_f32 v144, 0x3fb8aa3b, v144
  v_mfma_f32_32x32x16_bf16 v[192:207], a[136:139], a[56:59], v[192:207]
  ds_read_b64_tr_b16 a[136:137], v22 offset:0
  ds_read_b64_tr_b16 a[138:139], v22 offset:512
  buffer_load_dwordx4 v3, s[8:11], s82 offen offset:1024 lds
  v_mfma_f32_32x32x16_bf16 v[208:223], a[140:143], a[56:59], v[208:223]
  ds_read_b64_tr_b16 a[140:141], v26 offset:0
  ds_read_b64_tr_b16 a[142:143], v26 offset:512
  v_exp_f32 v144, v144
  s_nop 0
  v_cvt_pk_bf16_f32 v144, v144, v144
  v_lshlrev_b32 v144, 16, v144
  v_mfma_f32_32x32x16_bf16 v[160:175], a[144:147], a[60:63], v[160:175]
  ds_read_b128 a[68:71], v35 offset:16384
  ds_read_b64_tr_b16 a[144:145], v15 offset:0
  s_waitcnt lgkmcnt(8)
  ds_read_b64_tr_b16 a[146:147], v15 offset:512
  buffer_load_dwordx4 v4, s[12:15], s82 offen offset:2048 lds
  v_mfma_f32_32x32x16_bf16 v[176:191], a[148:151], a[60:63], v[176:191]
  ds_read_b64_tr_b16 a[148:149], v19 offset:0
  ds_read_b64_tr_b16 a[150:151], v19 offset:512
  v_mul_f32 v72, v144, v142
  v_mul_f32 v73, v144, v143
  v_mul_f32 v72, 0x3fb8aa3b, v72
  v_mul_f32 v73, 0.15915494, v73
  v_mul_f32 v74, 1.0, v72
  v_mul_f32 v75, 1.0, v73
  v_mfma_f32_32x32x16_bf16 v[192:207], a[152:155], a[60:63], v[192:207]
  ds_read_b64_tr_b16 a[152:153], v23 offset:0
  ds_read_b64_tr_b16 a[154:155], v23 offset:512
  buffer_load_dwordx4 v5, s[12:15], s82 offen offset:3072 lds
  s_add_u32 s82, s82, 229376
  s_cmp_eq_u32 s82, s83
  s_cselect_b32 s82, s58, s82
  v_mfma_f32_32x32x16_bf16 v[208:223], a[156:159], a[60:63], v[208:223]
  ds_read_b64_tr_b16 a[156:157], v27 offset:0
  ds_read_b64_tr_b16 a[158:159], v27 offset:512
  v_exp_f32 v74, v74
  v_mfma_f32_32x32x16_bf16 v[160:175], a[128:131], a[64:67], v[160:175]
  s_mul_i32 s71, s70, 1792
  buffer_load_dword v117, v115, s[36:39], s71 offen offset:0
  v_mfma_f32_16x16x32_bf16 a[176:179], v[104:107], a[128:131], a[176:179]
  s_waitcnt lgkmcnt(4)
  ds_read_b128 a[72:75], v36 offset:16384
  ds_read_b64_tr_b16 a[128:129], v16 offset:0
  ds_read_b64_tr_b16 a[130:131], v16 offset:512
  v_mfma_f32_32x32x16_bf16 v[176:191], a[132:135], a[64:67], v[176:191]
  s_lshl_b32 s71, s70, 9
  buffer_load_dword v117, v112, s[28:31], s71 offen offset:0
  v_fract_f32 v75, v75
  v_mfma_f32_16x16x32_bf16 a[180:183], v[104:107], a[132:135], a[180:183]
  ds_read_b64_tr_b16 a[132:133], v20 offset:0
  ds_read_b64_tr_b16 a[134:135], v20 offset:512
  v_mfma_f32_32x32x16_bf16 v[192:207], a[136:139], a[64:67], v[192:207]
  s_lshl_b32 s71, s70, 9
  buffer_load_dword v117, v112, s[32:35], s71 offen offset:0
  v_cos_f32 v38, v75
  v_mfma_f32_16x16x32_bf16 a[184:187], v[104:107], a[136:139], a[184:187]
  ds_read_b64_tr_b16 a[136:137], v24 offset:0
  ds_read_b64_tr_b16 a[138:139], v24 offset:512
  v_mfma_f32_32x32x16_bf16 v[208:223], a[140:143], a[64:67], v[208:223]
  s_nop 0
  v_sin_f32 v39, v75
  v_mul_f32 v38, v74, v38
  v_mfma_f32_16x16x32_bf16 a[188:191], v[104:107], a[140:143], a[188:191]
  ds_read_b64_tr_b16 a[140:141], v28 offset:0
  ds_read_b64_tr_b16 a[142:143], v28 offset:512
  v_mfma_f32_32x32x16_bf16 v[160:175], a[144:147], a[68:71], v[160:175]
  ds_read_b128 a[76:79], v37 offset:16384
  ds_read_b64_tr_b16 a[144:145], v17 offset:0
  s_waitcnt lgkmcnt(6)
  ds_read_b64_tr_b16 a[146:147], v17 offset:512
  v_mul_f32 v39, v74, v39
  v_sub_f32 v40, 0, v39
  v_mfma_f32_32x32x16_bf16 v[176:191], a[148:151], a[68:71], v[176:191]
  ds_read_b64_tr_b16 a[148:149], v21 offset:0
  ds_read_b64_tr_b16 a[150:151], v21 offset:512
  v_mul_f32 v76, v142, v142
  v_fmac_f32 v76, v143, v143
  v_rcp_f32 v76, v76
  v_mfma_f32_32x32x16_bf16 v[192:207], a[152:155], a[68:71], v[192:207]
  ds_read_b64_tr_b16 a[152:153], v25 offset:0
  ds_read_b64_tr_b16 a[154:155], v25 offset:512
  v_add_f32 v77, -1.0, v38
  v_mfma_f32_32x32x16_bf16 v[208:223], a[156:159], a[68:71], v[208:223]
  ds_read_b64_tr_b16 a[156:157], v29 offset:0
  ds_read_b64_tr_b16 a[158:159], v29 offset:512
  s_waitcnt vmcnt(13)
  s_barrier
  v_mfma_f32_32x32x16_bf16 v[160:175], a[128:131], a[72:75], v[160:175]
  ds_read_b128 a[80:83], v34 offset:0
  ds_read_b64_tr_b16 a[128:129], v14 offset:16384
  s_add_u32 m0, s97, 49152
  s_waitcnt lgkmcnt(8)
  ds_read_b64_tr_b16 a[130:131], v14 offset:16896
  buffer_load_dwordx4 v2, s[8:11], s82 offen offset:0 lds
  v_mfma_f32_32x32x16_bf16 v[176:191], a[132:135], a[72:75], v[176:191]
  ds_read_b64_tr_b16 a[132:133], v18 offset:16384
  ds_read_b64_tr_b16 a[134:135], v18 offset:16896
  v_add_f32 v76, v76, v76
  v_mul_f32 v41, v77, v142
  v_fmac_f32 v41, v39, v143
  v_mul_f32 v42, v39, v142
  v_fma_f32 v42, -v77, v143, v42
  v_mfma_f32_32x32x16_bf16 v[192:207], a[136:139], a[72:75], v[192:207]
  ds_read_b64_tr_b16 a[136:137], v22 offset:16384
  ds_read_b64_tr_b16 a[138:139], v22 offset:16896
  buffer_load_dwordx4 v3, s[8:11], s82 offen offset:1024 lds
  v_mfma_f32_32x32x16_bf16 v[208:223], a[140:143], a[72:75], v[208:223]
  ds_read_b64_tr_b16 a[140:141], v26 offset:16384
  ds_read_b64_tr_b16 a[142:143], v26 offset:16896
  v_mul_f32 v41, v41, v76
  v_mul_f32 v42, v42, v76
  v_mfma_f32_32x32x16_bf16 v[160:175], a[144:147], a[76:79], v[160:175]
  s_waitcnt lgkmcnt(6)
  ds_read_b128 a[84:87], v35 offset:0
  ds_read_b64_tr_b16 a[144:145], v15 offset:16384
  ds_read_b64_tr_b16 a[146:147], v15 offset:16896
  buffer_load_dwordx4 v4, s[12:15], s82 offen offset:2048 lds
  v_mul_f32 v74, 0x41800000, v72
  v_mul_f32 v75, 0x41800000, v73
  v_mfma_f32_32x32x16_bf16 v[176:191], a[148:151], a[76:79], v[176:191]
  ds_read_b64_tr_b16 a[148:149], v19 offset:16384
  ds_read_b64_tr_b16 a[150:151], v19 offset:16896
  v_exp_f32 v74, v74
  v_fract_f32 v75, v75
  v_cos_f32 v43, v75
  v_mfma_f32_32x32x16_bf16 v[192:207], a[152:155], a[76:79], v[192:207]
  ds_read_b64_tr_b16 a[152:153], v23 offset:16384
  ds_read_b64_tr_b16 a[154:155], v23 offset:16896
  buffer_load_dwordx4 v5, s[12:15], s82 offen offset:3072 lds
  s_add_u32 s82, s82, 229376
  s_cmp_eq_u32 s82, s83
  s_cselect_b32 s82, s58, s82
  s_and_b32 s57, s50, 3
  s_cmp_eq_u32 s57, 3
  s_cselect_b32 s57, 1, 0
  s_add_u32 s57, s57, s50
  s_lshl_b32 s57, s57, 5
  s_sub_u32 s57, 2048, s57
  s_add_u32 s58, s58, s57
  s_add_u32 s82, s82, s57
  s_add_u32 s83, s83, s57
  v_mfma_f32_32x32x16_bf16 v[208:223], a[156:159], a[76:79], v[208:223]
  ds_read_b64_tr_b16 a[156:157], v27 offset:16384
  ds_read_b64_tr_b16 a[158:159], v27 offset:16896
  v_mfma_f32_32x32x16_bf16 v[160:175], a[128:131], a[80:83], v[160:175]
  buffer_load_dwordx4 v[96:99], v100, s[24:27], s69 offen sc1
  v_sin_f32 v44, v75
  v_mfma_f32_16x16x32_bf16 a[176:179], v[104:107], a[128:131], a[176:179]
  s_waitcnt lgkmcnt(2)
  ds_read_b128 a[88:91], v36 offset:0
  ds_read_b64_tr_b16 a[128:129], v16 offset:16384
  ds_read_b64_tr_b16 a[130:131], v16 offset:16896
  v_mfma_f32_32x32x16_bf16 v[176:191], a[132:135], a[80:83], v[176:191]
  s_add_u32 m0, s61, 12288
  s_nop 0
  buffer_load_dwordx4 v6, s[16:19], s99 offen offset:0 lds
  v_mul_f32 v43, v74, v43
  v_mfma_f32_16x16x32_bf16 a[180:183], v[104:107], a[132:135], a[180:183]
  ds_read_b64_tr_b16 a[132:133], v20 offset:16384
  ds_read_b64_tr_b16 a[134:135], v20 offset:16896
  v_mfma_f32_32x32x16_bf16 v[192:207], a[136:139], a[80:83], v[192:207]
  buffer_load_dwordx4 v6, s[20:23], s99 offen offset:1024 lds
  s_add_u32 s99, s99, 128
  s_and_b32 s99, s99, 0xfffffbff
  v_mul_f32 v44, v74, v44
  v_mfma_f32_16x16x32_bf16 a[184:187], v[104:107], a[136:139], a[184:187]
  ds_read_b64_tr_b16 a[136:137], v24 offset:16384
  ds_read_b64_tr_b16 a[138:139], v24 offset:16896
  v_mfma_f32_32x32x16_bf16 v[208:223], a[140:143], a[80:83], v[208:223]
  s_nop 0
  v_mul_f32 v74, 0x43000000, v72
  v_mul_f32 v75, 0x43000000, v73
  v_exp_f32 v74, v74
  v_mfma_f32_16x16x32_bf16 a[188:191], v[104:107], a[140:143], a[188:191]
  ds_read_b64_tr_b16 a[140:141], v28 offset:16384
  ds_read_b64_tr_b16 a[142:143], v28 offset:16896
  v_mfma_f32_32x32x16_bf16 v[160:175], a[144:147], a[84:87], v[160:175]
  ds_read_b128 a[92:95], v37 offset:0
  ds_read_b64_tr_b16 a[144:145], v17 offset:16384
  ds_read_b64_tr_b16 a[146:147], v17 offset:16896
  v_fract_f32 v75, v75
  v_mfma_f32_32x32x16_bf16 v[176:191], a[148:151], a[84:87], v[176:191]
  ds_read_b64_tr_b16 a[148:149], v21 offset:16384
  s_waitcnt lgkmcnt(8)
  ds_read_b64_tr_b16 a[150:151], v21 offset:16896
  v_cos_f32 v47, v75
  v_sin_f32 v48, v75
  v_mul_f32 v47, v74, v47
  v_mfma_f32_32x32x16_bf16 v[192:207], a[152:155], a[84:87], v[192:207]
  ds_read_b64_tr_b16 a[152:153], v25 offset:16384
  ds_read_b64_tr_b16 a[154:155], v25 offset:16896
  v_mfma_f32_32x32x16_bf16 v[208:223], a[156:159], a[84:87], v[208:223]
  ds_read_b64_tr_b16 a[156:157], v29 offset:16384
  ds_read_b64_tr_b16 a[158:159], v29 offset:16896
  s_waitcnt vmcnt(10)
  s_barrier
  v_mfma_f32_32x32x16_bf16 v[160:175], a[128:131], a[88:91], v[160:175]
  ds_read_b128 a[96:99], v34 offset:4096
  ds_read_b64_tr_b16 a[128:129], v14 offset:32768
  s_add_u32 m0, s61, 14336
  s_waitcnt lgkmcnt(8)
  ds_read_b64_tr_b16 a[130:131], v14 offset:33280
  buffer_load_dwordx4 v6, s[16:19], s99 offen offset:0 lds
  v_mfma_f32_32x32x16_bf16 v[176:191], a[132:135], a[88:91], v[176:191]
  ds_read_b64_tr_b16 a[132:133], v18 offset:32768
  ds_read_b64_tr_b16 a[134:135], v18 offset:33280
  v_mul_f32 v48, v74, v48
  v_lshl_add_u32 v78, s48, 1, v139
  v_cvt_f32_u32 v78, v78
  v_mul_f32 v79, 0x41800000, v78
  v_mul_f32 v74, v79, v72
  v_mul_f32 v75, v79, v73
  v_mfma_f32_32x32x16_bf16 v[192:207], a[136:139], a[88:91], v[192:207]
  ds_read_b64_tr_b16 a[136:137], v22 offset:32768
  ds_read_b64_tr_b16 a[138:139], v22 offset:33280
  buffer_load_dwordx4 v6, s[20:23], s99 offen offset:1024 lds
  s_add_u32 s99, s99, 128
  s_and_b32 s99, s99, 0xfffffbff
  v_mfma_f32_32x32x16_bf16 v[208:223], a[140:143], a[88:91], v[208:223]
  ds_read_b64_tr_b16 a[140:141], v26 offset:32768
  ds_read_b64_tr_b16 a[142:143], v26 offset:33280
  v_exp_f32 v74, v74
  v_mfma_f32_32x32x16_bf16 v[160:175], a[144:147], a[92:95], v[160:175]
  s_waitcnt lgkmcnt(6)
  ds_read_b128 a[100:103], v35 offset:4096
  ds_read_b64_tr_b16 a[144:145], v15 offset:32768
  s_add_u32 m0, s97, 0
  ds_read_b64_tr_b16 a[146:147], v15 offset:33280
  buffer_load_dwordx4 v2, s[8:11], s82 offen offset:0 lds
  v_mfma_f32_32x32x16_bf16 v[176:191], a[148:151], a[92:95], v[176:191]
  ds_read_b64_tr_b16 a[148:149], v19 offset:32768
  ds_read_b64_tr_b16 a[150:151], v19 offset:33280
  v_fract_f32 v75, v75
  v_cos_f32 v45, v75
  v_mfma_f32_32x32x16_bf16 v[192:207], a[152:155], a[92:95], v[192:207]
  ds_read_b64_tr_b16 a[152:153], v23 offset:32768
  ds_read_b64_tr_b16 a[154:155], v23 offset:33280
  buffer_load_dwordx4 v3, s[8:11], s82 offen offset:1024 lds
  v_mfma_f32_32x32x16_bf16 v[208:223], a[156:159], a[92:95], v[208:223]
  ds_read_b64_tr_b16 a[156:157], v27 offset:32768
  ds_read_b64_tr_b16 a[158:159], v27 offset:33280
  v_sin_f32 v46, v75
  v_mul_f32 v45, v74, v45
  v_mfma_f32_32x32x16_bf16 v[160:175], a[128:131], a[96:99], v[160:175]
  buffer_load_dwordx4 v4, s[12:15], s82 offen offset:2048 lds
  v_mul_f32 v46, v74, v46
  v_sub_f32 v79, 0x40e00000, v78
  v_mul_f32 v79, 0x43800000, v79
  v_mfma_f32_16x16x32_bf16 a[176:179], v[104:107], a[128:131], a[176:179]
  s_waitcnt lgkmcnt(4)
  ds_read_b128 a[104:107], v36 offset:4096
  ds_read_b64_tr_b16 a[128:129], v16 offset:32768
  ds_read_b64_tr_b16 a[130:131], v16 offset:33280
  v_mfma_f32_32x32x16_bf16 v[176:191], a[132:135], a[96:99], v[176:191]
  buffer_load_dwordx4 v5, s[12:15], s82 offen offset:3072 lds
  s_add_u32 s82, s82, 229376
  s_cmp_eq_u32 s82, s83
  s_cselect_b32 s82, s58, s82
  v_mfma_f32_16x16x32_bf16 a[180:183], v[104:107], a[132:135], a[180:183]
  ds_read_b64_tr_b16 a[132:133], v20 offset:32768
  ds_read_b64_tr_b16 a[134:135], v20 offset:33280
  v_mul_f32 v74, v79, v72
  v_mul_f32 v75, v79, v73
  v_mfma_f32_32x32x16_bf16 v[192:207], a[136:139], a[96:99], v[192:207]
  s_add_u32 m0, s61, 16384
  s_nop 0
  buffer_load_dwordx4 v6, s[16:19], s99 offen offset:0 lds
  v_exp_f32 v74, v74
  v_mfma_f32_16x16x32_bf16 a[184:187], v[104:107], a[136:139], a[184:187]
  ds_read_b64_tr_b16 a[136:137], v24 offset:32768
  ds_read_b64_tr_b16 a[138:139], v24 offset:33280
  v_mfma_f32_32x32x16_bf16 v[208:223], a[140:143], a[96:99], v[208:223]
  buffer_load_dwordx4 v6, s[20:23], s99 offen offset:1024 lds
  s_add_u32 s99, s99, 128
  s_and_b32 s99, s99, 0xfffffbff
  v_mfma_f32_16x16x32_bf16 a[188:191], v[104:107], a[140:143], a[188:191]
  ds_read_b64_tr_b16 a[140:141], v28 offset:32768
  ds_read_b64_tr_b16 a[142:143], v28 offset:33280
  v_mfma_f32_32x32x16_bf16 v[160:175], a[144:147], a[100:103], v[160:175]
  ds_read_b128 a[108:111], v37 offset:4096
  ds_read_b64_tr_b16 a[144:145], v17 offset:32768
  s_waitcnt lgkmcnt(6)
  ds_read_b64_tr_b16 a[146:147], v17 offset:33280
  v_fract_f32 v75, v75
  v_mfma_f32_32x32x16_bf16 v[176:191], a[148:151], a[100:103], v[176:191]
  ds_read_b64_tr_b16 a[148:149], v21 offset:32768
  ds_read_b64_tr_b16 a[150:151], v21 offset:33280
  v_cos_f32 v49, v75
  v_sin_f32 v50, v75
  v_mul_f32 v49, v74, v49
  v_mfma_f32_32x32x16_bf16 v[192:207], a[152:155], a[100:103], v[192:207]
  ds_read_b64_tr_b16 a[152:153], v25 offset:32768
  ds_read_b64_tr_b16 a[154:155], v25 offset:33280
  v_mul_f32 v50, v74, v50
  v_mfma_f32_32x32x16_bf16 v[208:223], a[156:159], a[100:103], v[208:223]
  ds_read_b64_tr_b16 a[156:157], v29 offset:32768
  ds_read_b64_tr_b16 a[158:159], v29 offset:33280
  s_waitcnt vmcnt(11)
  s_barrier
  v_mfma_f32_32x32x16_bf16 v[160:175], a[128:131], a[104:107], v[160:175]
  ds_read_b128 a[112:115], v34 offset:8192
  ds_read_b64_tr_b16 a[128:129], v14 offset:49152
  s_add_u32 m0, s61, 18432
  s_waitcnt lgkmcnt(8)
  ds_read_b64_tr_b16 a[130:131], v14 offset:49664
  buffer_load_dwordx4 v6, s[16:19], s99 offen offset:0 lds
  v_mfma_f32_32x32x16_bf16 v[176:191], a[132:135], a[104:107], v[176:191]
  ds_read_b64_tr_b16 a[132:133], v18 offset:49152
  ds_read_b64_tr_b16 a[134:135], v18 offset:49664
  v_mfma_f32_32x32x16_bf16 v[192:207], a[136:139], a[104:107], v[192:207]
  ds_read_b64_tr_b16 a[136:137], v22 offset:49152
  ds_read_b64_tr_b16 a[138:139], v22 offset:49664
  buffer_load_dwordx4 v6, s[20:23], s99 offen offset:1024 lds
  s_add_u32 s99, s99, 128
  s_and_b32 s99, s99, 0xfffffbff
  v_mfma_f32_32x32x16_bf16 v[208:223], a[140:143], a[104:107], v[208:223]
  ds_read_b64_tr_b16 a[140:141], v26 offset:49152
  ds_read_b64_tr_b16 a[142:143], v26 offset:49664
  v_mfma_f32_32x32x16_bf16 v[160:175], a[144:147], a[108:111], v[160:175]
  s_waitcnt lgkmcnt(6)
  ds_read_b128 a[116:119], v35 offset:8192
  ds_read_b64_tr_b16 a[144:145], v15 offset:49152
  s_add_u32 m0, s97, 16384
  ds_read_b64_tr_b16 a[146:147], v15 offset:49664
  buffer_load_dwordx4 v2, s[8:11], s82 offen offset:0 lds
  v_mfma_f32_32x32x16_bf16 v[176:191], a[148:151], a[108:111], v[176:191]
  ds_read_b64_tr_b16 a[148:149], v19 offset:49152
  ds_read_b64_tr_b16 a[150:151], v19 offset:49664
  s_waitcnt vmcnt(13)
  v_xor_b32 v72, v51, v97
  v_xor_b32 v73, v51, v99
  v_or_b32 v72, v72, v73
  v_cmp_ne_u32 vcc, 0, v72
  s_and_b64 vcc, exec, vcc
  s_cbranch_vccz L_ok2
  s_mov_b32 s71, 30000
L_sp2:
  s_sleep 1
  buffer_load_dwordx4 v[96:99], v100, s[24:27], s69 offen sc1
  s_waitcnt vmcnt(0)
  v_xor_b32 v72, v51, v97
  v_xor_b32 v73, v51, v99
  v_or_b32 v72, v72, v73
  v_cmp_ne_u32 vcc, 0, v72
  s_and_b64 vcc, exec, vcc
  s_cbranch_vccz L_ok2
  s_sub_u32 s71, s71, 1
  s_cmp_lg_u32 s71, 0
  s_cbranch_scc1 L_sp2
L_ok2:
  v_rcp_f32 v72, v98
  v_mfma_f32_32x32x16_bf16 v[192:207], a[152:155], a[108:111], v[192:207]
  ds_read_b64_tr_b16 a[152:153], v23 offset:49152
  ds_read_b64_tr_b16 a[154:155], v23 offset:49664
  buffer_load_dwordx4 v3, s[8:11], s82 offen offset:1024 lds
  v_mov_b32 v56, v98
  v_cvt_pk_bf16_f32 v96, -v96, -v96
  v_mfma_f32_32x32x16_bf16 v[208:223], a[156:159], a[108:111], v[208:223]
  ds_read_b64_tr_b16 a[156:157], v27 offset:49152
  ds_read_b64_tr_b16 a[158:159], v27 offset:49664
  v_cmp_gt_u32 vcc, 512, v1
  s_nop 1
  v_cndmask_b32 v60, v61, v96, vcc
  s_waitcnt lgkmcnt(6)
  ds_write_b32 v59, v72
  v_mul_f32 v55, 0xbfb8aa3b, v72
  v_mfma_f32_32x32x16_bf16 v[160:175], a[128:131], a[112:115], v[160:175]
  buffer_load_dwordx4 v4, s[12:15], s82 offen offset:2048 lds
  v_mfma_f32_16x16x32_bf16 a[176:179], v[104:107], a[128:131], a[176:179]
  ds_read_b128 a[120:123], v36 offset:8192
  ds_read_b64_tr_b16 a[128:129], v16 offset:49152
  ds_read_b64_tr_b16 a[130:131], v16 offset:49664
  v_mfma_f32_32x32x16_bf16 v[176:191], a[132:135], a[112:115], v[176:191]
  buffer_load_dwordx4 v5, s[12:15], s82 offen offset:3072 lds
  s_add_u32 s82, s82, 229376
  s_cmp_eq_u32 s82, s83
  s_cselect_b32 s82, s58, s82
  v_mfma_f32_16x16x32_bf16 a[180:183], v[104:107], a[132:135], a[180:183]
  ds_read_b64_tr_b16 a[132:133], v20 offset:49152
  ds_read_b64_tr_b16 a[134:135], v20 offset:49664
  v_mfma_f32_32x32x16_bf16 v[192:207], a[136:139], a[112:115], v[192:207]
  s_add_u32 m0, s61, 20480
  s_nop 0
  buffer_load_dwordx4 v6, s[16:19], s99 offen offset:0 lds
  v_mfma_f32_16x16x32_bf16 a[184:187], v[104:107], a[136:139], a[184:187]
  ds_read_b64_tr_b16 a[136:137], v24 offset:49152
  ds_read_b64_tr_b16 a[138:139], v24 offset:49664
  v_mfma_f32_32x32x16_bf16 v[208:223], a[140:143], a[112:115], v[208:223]
  buffer_load_dwordx4 v6, s[20:23], s99 offen offset:1024 lds
  s_add_u32 s99, s99, 128
  s_and_b32 s99, s99, 0xfffffbff
  v_mfma_f32_16x16x32_bf16 a[188:191], v[104:107], a[140:143], a[188:191]
  ds_read_b64_tr_b16 a[140:141], v28 offset:49152
  s_waitcnt lgkmcnt(5)
  ds_read_b64_tr_b16 a[142:143], v28 offset:49664
  v_mfma_f32_32x32x16_bf16 v[160:175], a[144:147], a[116:119], v[160:175]
  ds_read_b128 a[124:127], v37 offset:8192
  ds_read_b64_tr_b16 a[144:145], v17 offset:49152
  ds_read_b64_tr_b16 a[146:147], v17 offset:49664
  ds_write2st64_b32 v110, a176, a177 offset0:16 offset1:17
  ds_write2st64_b32 v110, a180, a181 offset0:18 offset1:19
  ds_write2st64_b32 v110, a184, a185 offset0:20 offset1:21
  s_nop 1
  ds_write2st64_b32 v110, a188, a189 offset0:22 offset1:23
  v_mfma_f32_32x32x16_bf16 v[176:191], a[148:151], a[116:119], v[176:191]
  ds_read_b64_tr_b16 a[148:149], v21 offset:49152
  ds_read_b64_tr_b16 a[150:151], v21 offset:49664
  v_mfma_f32_32x32x16_bf16 v[192:207], a[152:155], a[116:119], v[192:207]
  s_waitcnt lgkmcnt(11)
  ds_read_b64_tr_b16 a[152:153], v25 offset:49152
  ds_read_b64_tr_b16 a[154:155], v25 offset:49664
  v_mfma_f32_32x32x16_bf16 v[208:223], a[156:159], a[116:119], v[208:223]
  ds_read_b64_tr_b16 a[156:157], v29 offset:49152
  ds_read_b64_tr_b16 a[158:159], v29 offset:49664
  s_waitcnt vmcnt(16) lgkmcnt(6)
  s_barrier
  v_mfma_f32_32x32x16_bf16 v[160:175], a[128:131], a[120:123], v[160:175]
  s_add_u32 m0, s97, 32768
  ds_read_b128 a[160:163], v30 offset:0
  buffer_load_dwordx4 v2, s[8:11], s82 offen offset:0 lds
  v_mfma_f32_32x32x16_bf16 v[176:191], a[132:135], a[120:123], v[176:191]
  ds_read_b128 a[164:167], v30 offset:1024
  v_mfma_f32_32x32x16_bf16 v[192:207], a[136:139], a[120:123], v[192:207]
  buffer_load_dwordx4 v3, s[8:11], s82 offen offset:1024 lds
  v_mfma_f32_32x32x16_bf16 v[208:223], a[140:143], a[120:123], v[208:223]
  v_mfma_f32_32x32x16_bf16 v[160:175], a[144:147], a[124:127], v[160:175]
  ds_read_b128 a[168:171], v31 offset:0
  ds_read_b128 v[72:75], v111 offset:4096
  buffer_load_dwordx4 v4, s[12:15], s82 offen offset:2048 lds
  s_waitcnt lgkmcnt(2)
  v_mfma_f32_32x32x16_bf16 v[176:191], a[148:151], a[124:127], v[176:191]
  ds_read_b128 a[172:175], v31 offset:1024
  ds_read_b128 v[76:79], v111 offset:4608
  s_waitcnt lgkmcnt(2)
  v_add_f32 v72, v72, v73
  s_waitcnt lgkmcnt(0)
  v_add_f32 v76, v76, v77
  v_add_f32 v74, v74, v75
  v_add_f32 v78, v78, v79
  v_add_f32 v72, v72, v74
  v_add_f32 v76, v76, v78
  v_and_b32 v73, 0xffff0000, v72
  v_mfma_f32_32x32x16_bf16 v[192:207], a[152:155], a[124:127], v[192:207]
  buffer_load_dwordx4 v5, s[12:15], s82 offen offset:3072 lds
  s_add_u32 s82, s82, 229376
  s_cmp_eq_u32 s82, s83
  s_cselect_b32 s82, s58, s82
  v_mfma_f32_32x32x16_bf16 v[208:223], a[156:159], a[124:127], v[208:223]
  s_nop 0
  v_and_b32 v77, 0xffff0000, v76
  v_sub_f32 v72, v72, v73
  v_sub_f32 v76, v76, v77
  v_cvt_pk_bf16_f32 v64, v73, v72
  v_cvt_pk_bf16_f32 v68, v77, v76
  s_nop 0
  v_mfma_f32_32x32x16_bf16 v[160:175], v[64:67], v[60:63], v[160:175]
  ds_read_b128 v[72:75], v111 offset:5120
  ds_read_b128 v[76:79], v111 offset:5632
  s_waitcnt lgkmcnt(1)
  v_add_f32 v72, v72, v73
  s_waitcnt lgkmcnt(0)
  v_add_f32 v76, v76, v77
  v_add_f32 v74, v74, v75
  v_mfma_f32_32x32x16_bf16 v[176:191], v[68:71], v[60:63], v[176:191]
  s_nop 0
  v_add_f32 v78, v78, v79
  v_add_f32 v72, v72, v74
  v_add_f32 v76, v76, v78
  v_and_b32 v73, 0xffff0000, v72
  v_and_b32 v77, 0xffff0000, v76
  v_sub_f32 v72, v72, v73
  v_mfma_f32_32x32x16_bf16 v[224:239], a[0:3], a[160:163], 0
  s_nop 0
  v_sub_f32 v76, v76, v77
  v_cvt_pk_bf16_f32 v64, v73, v72
  v_cvt_pk_bf16_f32 v68, v77, v76
  v_mfma_f32_16x16x32_bf16 a[176:179], v[104:107], a[160:163], 0
  ds_read_b128 a[160:163], v32 offset:0
  v_mfma_f32_32x32x16_bf16 v[240:255], a[0:3], a[164:167], 0
  v_mfma_f32_16x16x32_bf16 a[180:183], v[104:107], a[164:167], 0
  ds_read_b128 a[164:167], v32 offset:1024
  v_mfma_f32_32x32x16_bf16 v[192:207], v[64:67], v[60:63], v[192:207]
  s_add_u32 m0, s61, 0
  s_xor_b32 s92, s100, 0
  buffer_load_dwordx4 v11, s[36:39], s92 offen offset:0 lds
  v_mfma_f32_32x32x16_bf16 v[208:223], v[68:71], v[60:63], v[208:223]
  v_mfma_f32_32x32x16_bf16 v[224:239], a[4:7], a[168:171], v[224:239]
  ds_read_b128 a[168:171], v33 offset:0
  buffer_load_dwordx4 v12, s[36:39], s92 offen offset:1024 lds
  v_mfma_f32_32x32x16_bf16 v[240:255], a[4:7], a[172:175], v[240:255]
  ds_read_b128 a[172:175], v33 offset:1024
  s_waitcnt vmcnt(20)
  s_barrier
  s_waitcnt lgkmcnt(2)
  v_mfma_f32_32x32x16_bf16 v[224:239], a[8:11], a[160:163], v[224:239]
  s_add_u32 m0, s97, 49152
  ds_read_b128 a[160:163], v30 offset:2048
  buffer_load_dwordx4 v2, s[8:11], s82 offen offset:0 lds
  v_mul_f32 v160, v55, v160
  v_mul_f32 v161, v55, v161
  v_mul_f32 v162, v55, v162
  v_mfma_f32_32x32x16_bf16 v[240:255], a[8:11], a[164:167], v[240:255]
  ds_read_b128 a[164:167], v30 offset:3072
  v_mul_f32 v163, v55, v163
  v_mul_f32 v164, v55, v164
  v_mul_f32 v165, v55, v165
  v_mul_f32 v166, v55, v166
  v_mul_f32 v167, v55, v167
  v_exp_f32 v160, v160
  s_waitcnt lgkmcnt(3)
  v_mfma_f32_32x32x16_bf16 v[224:239], a[12:15], a[168:171], v[224:239]
  ds_read_b128 a[168:171], v31 offset:2048
  s_mul_i32 s56, s48, 196608
  s_add_u32 s56, s56, 1048576
  s_add_u32 s56, s56, s72
  buffer_load_dwordx4 v3, s[8:11], s82 offen offset:1024 lds
  s_waitcnt lgkmcnt(3)
  v_mfma_f32_32x32x16_bf16 v[240:255], a[12:15], a[172:175], v[240:255]
  ds_read_b128 a[172:175], v31 offset:3072
  v_exp_f32 v161, v161
  v_exp_f32 v162, v162
  v_exp_f32 v163, v163
  v_exp_f32 v164, v164
  v_exp_f32 v165, v165
  s_waitcnt lgkmcnt(2)
  v_mfma_f32_32x32x16_bf16 v[224:239], a[16:19], a[160:163], v[224:239]
  buffer_load_dwordx4 v4, s[12:15], s82 offen offset:2048 lds
  v_exp_f32 v166, v166
  v_exp_f32 v167, v167
  v_fma_f32 v160, v160, v56, v56
  v_fma_f32 v161, v161, v56, v56
  v_fma_f32 v162, v162, v56, v56
  v_fma_f32 v163, v163, v56, v56
  v_fma_f32 v164, v164, v56, v56
  v_bfe_u32 v9, v1, 7, 3
  v_mfma_f32_16x16x32_bf16 a[176:179], v[104:107], a[160:163], a[176:179]
  ds_read_b128 a[160:163], v32 offset:2048
  v_bfe_u32 v10, v1, 4, 3
  v_lshrrev_b32 v8, 1, v9
  v_xor_b32 v10, v10, v8
  v_lshlrev_b32 v9, 10, v9
  v_mfma_f32_32x32x16_bf16 v[240:255], a[16:19], a[164:167], v[240:255]
  buffer_load_dwordx4 v5, s[12:15], s82 offen offset:3072 lds
  s_add_u32 s82, s82, 229376
  s_cmp_eq_u32 s82, s83
  s_cselect_b32 s82, s58, s82
  v_lshl_add_u32 v7, v10, 4, v9
  v_xor_b32 v8, 64, v7
  v_add_u32 v8, 7168, v8
  v_add_u32 v9, 14336, v7
  v_add_u32 v10, 14336, v8
  v_mfma_f32_16x16x32_bf16 a[180:183], v[104:107], a[164:167], a[180:183]
  ds_read_b128 a[164:167], v32 offset:3072
  s_lshr_b32 s68, s55, 1
  s_xor_b32 s68, s68, s48
  s_lshl_b32 s68, s68, 5
  v_xor_b32 v34, s68, v34
  v_xor_b32 v35, s68, v35
  v_xor_b32 v36, s68, v36
  v_xor_b32 v37, s68, v37
  s_waitcnt lgkmcnt(2)
  v_mfma_f32_32x32x16_bf16 v[224:239], a[20:23], a[168:171], v[224:239]
  ds_read_b128 a[168:171], v33 offset:2048
  s_add_u32 m0, s61, 2048
  s_xor_b32 s92, s100, 16384
  buffer_load_dwordx4 v11, s[36:39], s92 offen offset:0 lds
  v_fma_f32 v165, v165, v56, v56
  v_fma_f32 v166, v166, v56, v56
  v_mfma_f32_32x32x16_bf16 v[240:255], a[20:23], a[172:175], v[240:255]
  ds_read_b128 a[172:175], v33 offset:3072
  v_fma_f32 v167, v167, v56, v56
  v_rcp_f32 v160, v160
  v_rcp_f32 v161, v161
  v_rcp_f32 v162, v162
  s_waitcnt vmcnt(19)
  s_barrier
  s_waitcnt lgkmcnt(3)
  v_mfma_f32_32x32x16_bf16 v[224:239], a[24:27], a[160:163], v[224:239]
  ds_read_b128 a[160:163], v30 offset:4096
  buffer_load_dwordx4 v12, s[36:39], s92 offen offset:1024 lds
  v_rcp_f32 v163, v163
  s_waitcnt lgkmcnt(3)
  v_mfma_f32_32x32x16_bf16 v[240:255], a[24:27], a[164:167], v[240:255]
  ds_read_b128 a[164:167], v30 offset:5120
  v_rcp_f32 v164, v164
  v_rcp_f32 v165, v165
  v_rcp_f32 v166, v166
  v_rcp_f32 v167, v167
  s_waitcnt lgkmcnt(3)
  v_mfma_f32_32x32x16_bf16 v[224:239], a[28:31], a[168:171], v[224:239]
  s_add_u32 m0, s61, 12288
  ds_read_b128 a[168:171], v31 offset:4096
  buffer_load_dwordx4 v6, s[16:19], s99 offen offset:0 lds
  v_mul_f32 v160, v160, v168
  v_mul_f32 v161, v161, v169
  s_waitcnt lgkmcnt(3)
  v_mfma_f32_32x32x16_bf16 v[240:255], a[28:31], a[172:175], v[240:255]
  ds_read_b128 a[172:175], v31 offset:5120
  v_mul_f32 v162, v162, v170
  v_mul_f32 v163, v163, v171
  v_mul_f32 v164, v164, v172
  v_mul_f32 v165, v165, v173
  v_mul_f32 v166, v166, v174
  v_mul_f32 v167, v167, v175
  v_cvt_pk_bf16_f32 v168, v160, v161
  s_waitcnt lgkmcnt(3)
  v_mfma_f32_32x32x16_bf16 v[224:239], a[32:35], a[160:163], v[224:239]
  s_and_b32 s68, s50, 3
  s_cmp_eq_u32 s68, 3
  s_cselect_b32 s68, 32, 0
  buffer_load_dwordx4 v6, s[20:23], s99 offen offset:1024 lds
  s_add_u32 s99, s99, 128
  s_and_b32 s99, s99, 0xfffffbff
  v_xor_b32 v18, s68, v14
  v_xor_b32 v19, s68, v15
  v_xor_b32 v20, s68, v16
  v_xor_b32 v21, s68, v17
  v_cvt_pk_bf16_f32 v169, v162, v163
  v_cvt_pk_bf16_f32 v170, v164, v165
  v_mfma_f32_16x16x32_bf16 a[176:179], v[104:107], a[160:163], a[176:179]
  ds_read_b128 a[160:163], v32 offset:4096
  s_add_u32 s68, s68, 32
  v_xor_b32 v22, s68, v14
  v_xor_b32 v23, s68, v15
  v_xor_b32 v24, s68, v16
  s_waitcnt lgkmcnt(2)
  v_mfma_f32_32x32x16_bf16 v[240:255], a[32:35], a[164:167], v[240:255]
  s_add_u32 m0, s61, 4096
  s_xor_b32 s92, s100, 32768
  buffer_load_dwordx4 v11, s[36:39], s92 offen offset:0 lds
  v_xor_b32 v25, s68, v17
  v_cvt_pk_bf16_f32 v171, v166, v167
  v_mfma_f32_16x16x32_bf16 a[180:183], v[104:107], a[164:167], a[180:183]
  ds_read_b128 a[164:167], v32 offset:5120
  s_add_u32 s68, s68, 32
  v_xor_b32 v26, s68, v14
  v_xor_b32 v27, s68, v15
  v_xor_b32 v28, s68, v16
  v_xor_b32 v29, s68, v17
  v_mfma_f32_32x32x16_bf16 v[224:239], a[36:39], a[168:171], v[224:239]
  ds_read_b128 a[168:171], v33 offset:4096
  buffer_store_dwordx4 v[168:171], v1, s[24:27], s62 offen offset:0 sc1
  v_mul_f32 v176, v55, v176
  v_mul_f32 v177, v55, v177
  v_mul_f32 v178, v55, v178
  v_mul_f32 v179, v55, v179
  v_mul_f32 v180, v55, v180
  v_mul_f32 v181, v55, v181
  v_mul_f32 v182, v55, v182
  v_mul_f32 v183, v55, v183
  s_waitcnt lgkmcnt(2)
  v_mfma_f32_32x32x16_bf16 v[240:255], a[36:39], a[172:175], v[240:255]
  ds_read_b128 a[172:175], v33 offset:5120
  v_exp_f32 v176, v176
  v_exp_f32 v177, v177
  v_exp_f32 v178, v178
  v_exp_f32 v179, v179
  s_waitcnt vmcnt(22)
  s_barrier
  v_mfma_f32_32x32x16_bf16 v[224:239], a[40:43], a[160:163], v[224:239]
  ds_read_b128 a[160:163], v30 offset:6144
  buffer_load_dwordx4 v12, s[36:39], s92 offen offset:1024 lds
  v_exp_f32 v180, v180
  s_waitcnt lgkmcnt(2)
  v_mfma_f32_32x32x16_bf16 v[240:255], a[40:43], a[164:167], v[240:255]
  ds_read_b128 a[164:167], v30 offset:7168
  v_exp_f32 v181, v181
  v_exp_f32 v182, v182
  v_exp_f32 v183, v183
  v_mfma_f32_32x32x16_bf16 v[224:239], a[44:47], a[168:171], v[224:239]
  s_add_u32 m0, s61, 14336
  ds_read_b128 a[168:171], v31 offset:6144
  buffer_load_dwordx4 v6, s[16:19], s99 offen offset:0 lds
  v_fma_f32 v176, v176, v56, v56
  v_fma_f32 v177, v177, v56, v56
  v_fma_f32 v178, v178, v56, v56
  s_waitcnt lgkmcnt(3)
  v_mfma_f32_32x32x16_bf16 v[240:255], a[44:47], a[172:175], v[240:255]
  ds_read_b128 a[172:175], v31 offset:7168
  buffer_load_dwordx4 v6, s[20:23], s99 offen offset:1024 lds
  s_add_u32 s99, s99, 128
  s_and_b32 s99, s99, 0xfffffbff
  v_fma_f32 v179, v179, v56, v56
  v_fma_f32 v180, v180, v56, v56
  v_fma_f32 v181, v181, v56, v56
  v_fma_f32 v182, v182, v56, v56
  v_fma_f32 v183, v183, v56, v56
  v_rcp_f32 v176, v176
  s_waitcnt lgkmcnt(3)
  v_mfma_f32_32x32x16_bf16 v[224:239], a[48:51], a[160:163], v[224:239]
  s_nop 0
  v_rcp_f32 v177, v177
  v_rcp_f32 v178, v178
  v_rcp_f32 v179, v179
  v_rcp_f32 v180, v180
  v_rcp_f32 v181, v181
  v_mfma_f32_16x16x32_bf16 a[176:179], v[104:107], a[160:163], a[176:179]
  ds_read_b128 a[160:163], v32 offset:6144
  v_bfe_u32 v76, v1, 4, 5
  v_bfe_u32 v77, v1, 9, 1
  s_waitcnt lgkmcnt(2)
  v_mfma_f32_32x32x16_bf16 v[240:255], a[48:51], a[164:167], v[240:255]
  s_add_u32 m0, s61, 6144
  s_xor_b32 s92, s100, 49152
  buffer_load_dwordx4 v11, s[36:39], s92 offen offset:0 lds
  v_lshlrev_b32 v76, 6, v76
  v_lshlrev_b32 v15, 1, v77
  v_mfma_f32_16x16x32_bf16 a[180:183], v[104:107], a[164:167], a[180:183]
  ds_read_b128 a[164:167], v32 offset:7168
  v_mfma_f32_32x32x16_bf16 v[224:239], a[52:55], a[168:171], v[224:239]
  ds_read_b128 a[168:171], v33 offset:6144
  buffer_load_dwordx4 v12, s[36:39], s92 offen offset:1024 lds
  v_rcp_f32 v182, v182
  v_rcp_f32 v183, v183
  s_waitcnt lgkmcnt(3)
  v_mfma_f32_32x32x16_bf16 v[240:255], a[52:55], a[172:175], v[240:255]
  ds_read_b128 a[172:175], v33 offset:7168
  v_mul_f32 v176, v176, v184
  v_mul_f32 v177, v177, v185
  v_mul_f32 v178, v178, v186
  v_mul_f32 v179, v179, v187
  v_bfe_u32 v14, v1, 5, 2
  v_xor_b32 v14, v14, v15
  v_lshl_add_u32 v76, v14, 4, v76
  v_add_u32 v14, s61, v76
  s_waitcnt vmcnt(21)
  s_barrier
  s_waitcnt lgkmcnt(3)
  v_mfma_f32_32x32x16_bf16 v[224:239], a[56:59], a[160:163], v[224:239]
  s_add_u32 m0, s61, 16384
  ds_read_b128 a[160:163], v30 offset:8192
  buffer_load_dwordx4 v6, s[16:19], s99 offen offset:0 lds
  v_mul_f32 v180, v180, v188
  v_mul_f32 v181, v181, v189
  v_mul_f32 v182, v182, v190
  v_mul_f32 v183, v183, v191
  v_cvt_pk_bf16_f32 v184, v176, v177
  s_waitcnt lgkmcnt(3)
  v_mfma_f32_32x32x16_bf16 v[240:255], a[56:59], a[164:167], v[240:255]
  ds_read_b128 a[164:167], v30 offset:9216
  v_cvt_pk_bf16_f32 v185, v178, v179
  v_cvt_pk_bf16_f32 v186, v180, v181
  v_cvt_pk_bf16_f32 v187, v182, v183
  v_xor_b32 v15, 16, v14
  v_bfe_u32 v76, v1, 6, 2
  v_lshl_add_u32 v76, v77, 3, v76
  buffer_store_dwordx4 v[184:187], v1, s[24:27], s62 offen offset:1024 sc1
  s_waitcnt lgkmcnt(2)
  v_mfma_f32_32x32x16_bf16 v[224:239], a[60:63], a[168:171], v[224:239]
  ds_read_b128 a[168:171], v31 offset:8192
  v_mul_f32 v192, v55, v192
  v_mul_f32 v193, v55, v193
  v_mul_f32 v194, v55, v194
  v_mul_f32 v195, v55, v195
  v_mul_f32 v196, v55, v196
  v_mul_f32 v197, v55, v197
  v_mul_f32 v198, v55, v198
  v_mul_f32 v199, v55, v199
  v_lshlrev_b32 v76, 6, v76
  v_mfma_f32_32x32x16_bf16 v[240:255], a[60:63], a[172:175], v[240:255]
  ds_read_b128 a[172:175], v31 offset:9216
  buffer_load_dwordx4 v6, s[20:23], s99 offen offset:1024 lds
  v_exp_f32 v192, v192
  v_bfe_u32 v77, v1, 4, 1
  v_bfe_u32 v17, v1, 8, 1
  v_lshl_add_u32 v77, v77, 1, v17
  s_waitcnt lgkmcnt(3)
  v_mfma_f32_32x32x16_bf16 v[224:239], a[64:67], a[160:163], v[224:239]
  s_waitcnt vmcnt(18)
  ds_read_b64_tr_b16 a[192:193], v57 offset:0
  ds_read_b64_tr_b16 a[194:195], v57 offset:512
  ds_read_b64_tr_b16 a[196:197], v58 offset:0
  ds_read_b64_tr_b16 a[198:199], v58 offset:512
  v_exp_f32 v193, v193
  v_exp_f32 v194, v194
  v_exp_f32 v195, v195
  v_bfe_u32 v17, v1, 7, 1
  v_mfma_f32_16x16x32_bf16 a[176:179], v[104:107], a[160:163], a[176:179]
  ds_read_b128 a[160:163], v32 offset:8192
  v_exp_f32 v196, v196
  s_waitcnt lgkmcnt(6)
  v_mfma_f32_32x32x16_bf16 v[240:255], a[64:67], a[164:167], v[240:255]
  s_add_u32 m0, s61, 8192
  s_xor_b32 s92, s100, 65536
  buffer_load_dwordx4 v11, s[36:39], s92 offen offset:0 lds
  v_exp_f32 v197, v197
  v_xor_b32 v77, v77, v17
  v_lshl_add_u32 v76, v77, 4, v76
  v_bfe_u32 v77, v1, 5, 1
  v_mfma_f32_16x16x32_bf16 a[180:183], v[104:107], a[164:167], a[180:183]
  ds_read_b128 a[164:167], v32 offset:9216
  v_mfma_f32_32x32x16_bf16 v[224:239], a[68:71], a[168:171], v[224:239]
  ds_read_b128 a[168:171], v33 offset:8192
  s_waitcnt vmcnt(13)
  ds_read_b64_tr_b16 a[200:201], v57 offset:2048
  ds_read_b64_tr_b16 a[202:203], v57 offset:2560
  ds_read_b64_tr_b16 a[204:205], v58 offset:2048
  ds_read_b64_tr_b16 a[206:207], v58 offset:2560
  buffer_load_dwordx4 v12, s[36:39], s92 offen offset:1024 lds
  v_exp_f32 v198, v198
  s_waitcnt lgkmcnt(7)
  v_mfma_f32_32x32x16_bf16 v[240:255], a[68:71], a[172:175], v[240:255]
  ds_read_b128 a[172:175], v33 offset:9216
  v_exp_f32 v199, v199
  v_fma_f32 v192, v192, v56, v56
  v_fma_f32 v193, v193, v56, v56
  v_fma_f32 v194, v194, v56, v56
  v_fma_f32 v195, v195, v56, v56
  v_fma_f32 v196, v196, v56, v56
  v_lshl_add_u32 v76, v77, 3, v76
  v_add_u32 v16, s61, v76
  v_xor_b32 v17, 32, v16
  s_waitcnt vmcnt(12)
  s_barrier
  s_waitcnt lgkmcnt(7)
  v_mfma_f32_32x32x16_bf16 v[224:239], a[72:75], a[160:163], v[224:239]
  ds_read_b128 a[160:163], v30 offset:0
  s_add_u32 m0, s61, 10240
  s_xor_b32 s92, s100, 81920
  buffer_load_dwordx4 v11, s[36:39], s92 offen offset:0 lds
  v_fma_f32 v197, v197, v56, v56
  v_fma_f32 v198, v198, v56, v56
  s_waitcnt lgkmcnt(5)
  v_mfma_f32_32x32x16_bf16 v[240:255], a[72:75], a[164:167], v[240:255]
  ds_read_b128 a[164:167], v30 offset:1024
  v_fma_f32 v199, v199, v56, v56
  v_rcp_f32 v192, v192
  v_rcp_f32 v193, v193
  v_rcp_f32 v194, v194
  v_mfma_f32_32x32x16_bf16 v[224:239], a[76:79], a[168:171], v[224:239]
  ds_read_b128 a[168:171], v31 offset:0
  buffer_load_dwordx4 v12, s[36:39], s92 offen offset:1024 lds
  v_rcp_f32 v195, v195
  s_waitcnt lgkmcnt(3)
  v_mfma_f32_32x32x16_bf16 v[240:255], a[76:79], a[172:175], v[240:255]
  ds_read_b128 a[172:175], v31 offset:1024
  v_rcp_f32 v196, v196
  v_rcp_f32 v197, v197
  v_rcp_f32 v198, v198
  v_rcp_f32 v199, v199
  s_waitcnt lgkmcnt(3)
  v_mfma_f32_32x32x16_bf16 v[224:239], a[80:83], a[160:163], v[224:239]
  s_waitcnt vmcnt(11)
  ds_read_b64_tr_b16 a[208:209], v57 offset:4096
  ds_read_b64_tr_b16 a[210:211], v57 offset:4608
  ds_read_b64_tr_b16 a[212:213], v58 offset:4096
  ds_read_b64_tr_b16 a[214:215], v58 offset:4608
  s_add_u32 m0, s61, 0
  s_xor_b32 s92, s100, 98304
  buffer_load_dwordx4 v11, s[36:39], s92 offen offset:0 lds
  v_mfma_f32_16x16x32_bf16 a[176:179], v[104:107], a[160:163], a[176:179]
  ds_read_b128 a[160:163], v32 offset:0
  v_mul_f32 v192, v192, v200
  v_mul_f32 v193, v193, v201
  v_mul_f32 v194, v194, v202
  s_waitcnt lgkmcnt(6)
  v_mfma_f32_32x32x16_bf16 v[240:255], a[80:83], a[164:167], v[240:255]
  buffer_load_dwordx4 v12, s[36:39], s92 offen offset:1024 lds
  v_mul_f32 v195, v195, v203
  v_mul_f32 v196, v196, v204
  v_mul_f32 v197, v197, v205
  v_mul_f32 v198, v198, v206
  v_mfma_f32_16x16x32_bf16 a[180:183], v[104:107], a[164:167], a[180:183]
  ds_read_b128 a[164:167], v32 offset:1024
  v_mul_f32 v199, v199, v207
  v_cvt_pk_bf16_f32 v200, v192, v193
  v_mfma_f32_32x32x16_bf16 v[224:239], a[84:87], a[168:171], v[224:239]
  ds_read_b128 a[168:171], v33 offset:0
  s_waitcnt vmcnt(9)
  ds_read_b64_tr_b16 a[216:217], v57 offset:6144
  ds_read_b64_tr_b16 a[218:219], v57 offset:6656
  ds_read_b64_tr_b16 a[220:221], v58 offset:6144
  ds_read_b64_tr_b16 a[222:223], v58 offset:6656
  s_add_u32 m0, s61, 2048
  s_xor_b32 s92, s100, 114688
  buffer_load_dwordx4 v11, s[36:39], s92 offen offset:0 lds
  v_cvt_pk_bf16_f32 v201, v194, v195
  s_waitcnt lgkmcnt(7)
  v_mfma_f32_32x32x16_bf16 v[240:255], a[84:87], a[172:175], v[240:255]
  ds_read_b128 a[172:175], v33 offset:1024
  v_cvt_pk_bf16_f32 v202, v196, v197
  v_cvt_pk_bf16_f32 v203, v198, v199
  buffer_store_dwordx4 v[200:203], v1, s[24:27], s62 offen offset:2048 sc1
  v_mul_f32 v208, v55, v208
  v_mul_f32 v209, v55, v209
  v_mul_f32 v210, v55, v210
  v_mul_f32 v211, v55, v211
  v_mul_f32 v212, v55, v212
  s_barrier
  s_waitcnt lgkmcnt(7)
  v_mfma_f32_32x32x16_bf16 v[224:239], a[88:91], a[160:163], v[224:239]
  ds_read_b128 a[160:163], v30 offset:2048
  v_mul_f32 v213, v55, v213
  v_mul_f32 v214, v55, v214
  v_mul_f32 v215, v55, v215
  v_exp_f32 v208, v208
  v_exp_f32 v209, v209
  s_waitcnt lgkmcnt(5)
  v_mfma_f32_32x32x16_bf16 v[240:255], a[88:91], a[164:167], v[240:255]
  ds_read_b128 a[164:167], v30 offset:3072
  buffer_load_dwordx4 v12, s[36:39], s92 offen offset:1024 lds
  v_exp_f32 v210, v210
  v_exp_f32 v211, v211
  v_mfma_f32_32x32x16_bf16 v[224:239], a[92:95], a[168:171], v[224:239]
  ds_read_b128 a[168:171], v31 offset:2048
  v_exp_f32 v212, v212
  v_exp_f32 v213, v213
  s_waitcnt lgkmcnt(3)
  v_mfma_f32_32x32x16_bf16 v[240:255], a[92:95], a[172:175], v[240:255]
  ds_read_b128 a[172:175], v31 offset:3072
  v_exp_f32 v214, v214
  v_exp_f32 v215, v215
  s_waitcnt lgkmcnt(3)
  v_mfma_f32_32x32x16_bf16 v[224:239], a[96:99], a[160:163], v[224:239]
  s_waitcnt vmcnt(7)
  ds_read_b64_tr_b16 a[224:225], v57 offset:8192
  ds_read_b64_tr_b16 a[226:227], v57 offset:8704
  ds_read_b64_tr_b16 a[228:229], v58 offset:8192
  ds_read_b64_tr_b16 a[230:231], v58 offset:8704
  v_fma_f32 v208, v208, v56, v56
  v_fma_f32 v209, v209, v56, v56
  v_mfma_f32_16x16x32_bf16 a[176:179], v[104:107], a[160:163], a[176:179]
  ds_read_b128 a[160:163], v32 offset:2048
  s_waitcnt lgkmcnt(7)
  v_mfma_f32_32x32x16_bf16 v[240:255], a[96:99], a[164:167], v[240:255]
  s_nop 0
  v_fma_f32 v210, v210, v56, v56
  v_fma_f32 v211, v211, v56, v56
  v_fma_f32 v212, v212, v56, v56
  v_fma_f32 v213, v213, v56, v56
  v_fma_f32 v214, v214, v56, v56
  v_fma_f32 v215, v215, v56, v56
  v_rcp_f32 v208, v208
  v_mfma_f32_16x16x32_bf16 a[180:183], v[104:107], a[164:167], a[180:183]
  ds_read_b128 a[164:167], v32 offset:3072
  s_waitcnt lgkmcnt(6)
  v_mfma_f32_32x32x16_bf16 v[224:239], a[100:103], a[168:171], v[224:239]
  ds_read_b128 a[168:171], v33 offset:2048
  s_waitcnt vmcnt(5)
  ds_read_b64_tr_b16 a[232:233], v57 offset:10240
  ds_read_b64_tr_b16 a[234:235], v57 offset:10752
  ds_read_b64_tr_b16 a[236:237], v58 offset:10240
  v_rcp_f32 v209, v209
  v_rcp_f32 v210, v210
  v_mfma_f32_32x32x16_bf16 v[240:255], a[100:103], a[172:175], v[240:255]
  ds_read_b128 a[172:175], v33 offset:3072
  ds_read_b64_tr_b16 a[238:239], v58 offset:10752
  v_rcp_f32 v211, v211
  v_rcp_f32 v212, v212
  v_rcp_f32 v213, v213
  s_barrier
  s_waitcnt lgkmcnt(7)
  v_mfma_f32_32x32x16_bf16 v[224:239], a[104:107], a[160:163], v[224:239]
  ds_read_b128 a[160:163], v30 offset:4096
  v_rcp_f32 v214, v214
  v_rcp_f32 v215, v215
  s_waitcnt lgkmcnt(7)
  v_mfma_f32_32x32x16_bf16 v[240:255], a[104:107], a[164:167], v[240:255]
  ds_read_b128 a[164:167], v30 offset:5120
  v_mul_f32 v208, v208, v216
  v_mul_f32 v209, v209, v217
  v_mul_f32 v210, v210, v218
  v_mul_f32 v211, v211, v219
  s_waitcnt lgkmcnt(4)
  v_mfma_f32_32x32x16_bf16 v[224:239], a[108:111], a[168:171], v[224:239]
  ds_read_b128 a[168:171], v31 offset:4096
  s_add_u32 m0, s61, 4096
  s_xor_b32 s93, s73, 0
  buffer_load_dwordx4 v7, s[28:31], s93 offen offset:0 lds
  v_mul_f32 v212, v212, v220
  v_mul_f32 v213, v213, v221
  v_mul_f32 v214, v214, v222
  s_waitcnt lgkmcnt(3)
  v_mfma_f32_32x32x16_bf16 v[240:255], a[108:111], a[172:175], v[240:255]
  ds_read_b128 a[172:175], v31 offset:5120
  v_mul_f32 v215, v215, v223
  v_cvt_pk_bf16_f32 v216, v208, v209
  v_cvt_pk_bf16_f32 v217, v210, v211
  v_cvt_pk_bf16_f32 v218, v212, v213
  v_cvt_pk_bf16_f32 v219, v214, v215
  buffer_store_dwordx4 v[216:219], v1, s[24:27], s62 offen offset:3072 sc1
  s_waitcnt lgkmcnt(3)
  v_mfma_f32_32x32x16_bf16 v[224:239], a[112:115], a[160:163], v[224:239]
  v_mfma_f32_16x16x32_bf16 a[176:179], v[104:107], a[160:163], a[176:179]
  ds_read_b128 a[160:163], v32 offset:4096
  s_waitcnt lgkmcnt(3)
  v_mfma_f32_32x32x16_bf16 v[240:255], a[112:115], a[164:167], v[240:255]
  buffer_load_dwordx4 v8, s[28:31], s93 offen offset:1024 lds
  v_mfma_f32_16x16x32_bf16 a[180:183], v[104:107], a[164:167], a[180:183]
  ds_read_b128 a[164:167], v32 offset:5120
  s_waitcnt lgkmcnt(2)
  v_mfma_f32_32x32x16_bf16 v[224:239], a[116:119], a[168:171], v[224:239]
  ds_read_b128 a[168:171], v33 offset:4096
  s_nop 2
  ds_write2st64_b32 v110, a176, a177 offset0:16 offset1:17
  s_nop 3
  ds_write2st64_b32 v110, a180, a181 offset0:18 offset1:19
  s_waitcnt vmcnt(6)
  ds_read_b64_tr_b16 a[240:241], v57 offset:0
  ds_read_b64_tr_b16 a[242:243], v57 offset:512
  buffer_load_dwordx4 v9, s[28:31], s93 offen offset:2048 lds
  v_mfma_f32_32x32x16_bf16 v[240:255], a[116:119], a[172:175], v[240:255]
  ds_read_b128 a[172:175], v33 offset:5120
  ds_read_b64_tr_b16 a[244:245], v58 offset:0
  ds_read_b64_tr_b16 a[246:247], v58 offset:512
  s_waitcnt lgkmcnt(5)
  s_barrier
  v_mfma_f32_32x32x16_bf16 v[224:239], a[120:123], a[160:163], v[224:239]
  ds_read_b64_tr_b16 a[128:129], v18 offset:0
  ds_read_b64_tr_b16 a[130:131], v18 offset:512
  ds_read_b64_tr_b16 a[132:133], v22 offset:0
  ds_read_b128 v[80:83], v103 offset:0
  s_waitcnt vmcnt(4)
  buffer_load_dwordx4 v10, s[28:31], s93 offen offset:3072 lds
  v_mfma_f32_32x32x16_bf16 v[240:255], a[120:123], a[164:167], v[240:255]
  ds_read_b64_tr_b16 a[134:135], v22 offset:512
  ds_read_b64_tr_b16 a[136:137], v26 offset:0
  ds_read_b64_tr_b16 a[138:139], v26 offset:512
  ds_read_b128 v[84:87], v103 offset:16
  ds_read_b128 v[88:91], v103 offset:32
  ds_read_b128 v[92:95], v103 offset:48
  s_waitcnt lgkmcnt(14)
  ds_read_b64_tr_b16 a[248:249], v57 offset:2048
  s_waitcnt lgkmcnt(14)
  ds_read_b64_tr_b16 a[250:251], v57 offset:2560
  s_waitcnt lgkmcnt(14)
  ds_read_b64_tr_b16 a[252:253], v58 offset:2048
  s_waitcnt lgkmcnt(14)
  ds_read_b64_tr_b16 a[254:255], v58 offset:2560
  v_mfma_f32_32x32x16_bf16 v[224:239], a[124:127], a[168:171], v[224:239]
  s_waitcnt lgkmcnt(14)
  ds_read_b64_tr_b16 a[144:145], v19 offset:0
  s_waitcnt lgkmcnt(14)
  ds_read_b64_tr_b16 a[146:147], v19 offset:512
  s_waitcnt lgkmcnt(14)
  ds_read_b64_tr_b16 a[148:149], v23 offset:0
  s_waitcnt lgkmcnt(14)
  ds_read_b128 v[72:75], v111 offset:4096
  s_waitcnt lgkmcnt(14)
  ds_read_b128 v[76:79], v111 offset:4608
  s_add_u32 m0, s61, 8192
  s_xor_b32 s93, s73, 32768
  buffer_load_dwordx4 v7, s[28:31], s93 offen offset:0 lds
  s_waitcnt lgkmcnt(1)
  v_add_f32 v72, v72, v73
  s_waitcnt lgkmcnt(0)
  v_add_f32 v76, v76, v77
  v_mfma_f32_32x32x16_bf16 v[240:255], a[124:127], a[172:175], v[240:255]
  ds_read_b64_tr_b16 a[150:151], v23 offset:512
  ds_read_b64_tr_b16 a[152:153], v27 offset:0
  ds_read_b64_tr_b16 a[154:155], v27 offset:512
  v_add_f32 v74, v74, v75
  v_add_f32 v78, v78, v79
  v_add_f32 v72, v72, v74
  v_add_f32 v76, v76, v78
  v_and_b32 v73, 0xffff0000, v72
  v_and_b32 v77, 0xffff0000, v76
  v_sub_f32 v72, v72, v73
  v_sub_f32 v76, v76, v77
  v_cvt_pk_bf16_f32 v64, v73, v72
  v_cvt_pk_bf16_f32 v68, v77, v76
  s_nop 0
  v_mfma_f32_32x32x16_bf16 v[224:239], v[60:63], v[64:67], v[224:239]
  buffer_load_dwordx4 v8, s[28:31], s93 offen offset:1024 lds
  v_add_u32 v32, 14336, v11
  v_mfma_f32_32x32x16_bf16 v[240:255], v[60:63], v[68:71], v[240:255]
  s_nop 0
  v_add_u32 v33, 14336, v12
  v_mfma_f32_32x32x16_bf16 v[112:127], a[128:131], a[0:3], 0
  buffer_load_dwordx4 v9, s[28:31], s93 offen offset:2048 lds
  v_mfma_f32_16x16x32_bf16 a[176:179], v[104:107], a[128:131], 0
  ds_read_b64_tr_b16 a[128:129], v20 offset:0
  ds_read_b64_tr_b16 a[130:131], v20 offset:512
  v_mfma_f32_32x32x16_bf16 v[128:143], a[132:135], a[0:3], 0
  buffer_load_dwordx4 v10, s[28:31], s93 offen offset:3072 lds
  v_mfma_f32_16x16x32_bf16 a[180:183], v[104:107], a[132:135], 0
  ds_read_b64_tr_b16 a[132:133], v24 offset:0
  ds_read_b64_tr_b16 a[134:135], v24 offset:512
  v_mfma_f32_32x32x16_bf16 v[144:159], a[136:139], a[0:3], 0
  v_mfma_f32_16x16x32_bf16 a[184:187], v[104:107], a[136:139], 0
  ds_read_b64_tr_b16 a[136:137], v28 offset:0
  ds_read_b64_tr_b16 a[138:139], v28 offset:512
  v_mfma_f32_32x32x16_bf16 v[112:127], a[144:147], a[4:7], v[112:127]
  ds_read_b64_tr_b16 a[144:145], v21 offset:0
  ds_read_b64_tr_b16 a[146:147], v21 offset:512
  v_mul_f32 v224, v80, v224
  v_mul_f32 v240, v80, v240
  v_mul_f32 v225, v81, v225
  v_mul_f32 v241, v81, v241
  v_mul_f32 v226, v82, v226
  v_mul_f32 v242, v82, v242
  v_mul_f32 v227, v83, v227
  v_mul_f32 v243, v83, v243
  v_mul_f32 v228, v84, v228
  v_mul_f32 v244, v84, v244
  v_mul_f32 v229, v85, v229
  v_mul_f32 v245, v85, v245
  v_mul_f32 v230, v86, v230
  v_mul_f32 v246, v86, v246
  v_mul_f32 v231, v87, v231
  v_mul_f32 v247, v87, v247
  v_mul_f32 v232, v88, v232
  v_mul_f32 v248, v88, v248
  v_mul_f32 v233, v89, v233
  v_mul_f32 v249, v89, v249
  v_mul_f32 v234, v90, v234
  v_mul_f32 v250, v90, v250
  v_mul_f32 v235, v91, v235
  v_mul_f32 v251, v91, v251
  v_mul_f32 v236, v92, v236
  v_mul_f32 v252, v92, v252
  v_mul_f32 v237, v93, v237
  v_mul_f32 v253, v93, v253
  v_mul_f32 v238, v94, v238
  v_mul_f32 v254, v94, v254
  v_mul_f32 v239, v95, v239
  s_waitcnt lgkmcnt(0)
  v_mfma_f32_32x32x16_bf16 v[128:143], a[148:151], a[4:7], v[128:143]
  ds_read_b64_tr_b16 a[148:149], v25 offset:0
  ds_read_b64_tr_b16 a[150:151], v25 offset:512
  v_mul_f32 v255, v95, v255
  v_fma_f32 v100, v38, v224, v225
  v_fma_f32 v101, v38, v240, v241
  v_fmac_f32 v100, v40, v240
  v_fmac_f32 v101, v39, v224
  v_fma_f32 v102, v38, v100, v226
  v_fma_f32 v103, v38, v101, v242
  v_fmac_f32 v102, v40, v101
  v_fmac_f32 v103, v39, v100
  v_fma_f32 v100, v38, v102, v227
  v_fma_f32 v101, v38, v103, v243
  v_fmac_f32 v100, v40, v103
  v_fmac_f32 v101, v39, v102
  v_fma_f32 v102, v38, v100, v228
  v_fma_f32 v103, v38, v101, v244
  v_fmac_f32 v102, v40, v101
  v_fmac_f32 v103, v39, v100
  v_fma_f32 v100, v38, v102, v229
  v_fma_f32 v101, v38, v103, v245
  v_fmac_f32 v100, v40, v103
  v_fmac_f32 v101, v39, v102
  v_fma_f32 v102, v38, v100, v230
  v_fma_f32 v103, v38, v101, v246
  v_fmac_f32 v102, v40, v101
  v_fmac_f32 v103, v39, v100
  v_fma_f32 v100, v38, v102, v231
  v_fma_f32 v101, v38, v103, v247
  v_fmac_f32 v100, v40, v103
  v_fmac_f32 v101, v39, v102
  v_fma_f32 v102, v38, v100, v232
  v_fma_f32 v103, v38, v101, v248
  v_mfma_f32_32x32x16_bf16 v[144:159], a[152:155], a[4:7], v[144:159]
  ds_read_b64_tr_b16 a[152:153], v29 offset:0
  ds_read_b64_tr_b16 a[154:155], v29 offset:512
  v_fmac_f32 v102, v40, v101
  v_fmac_f32 v103, v39, v100
  v_fma_f32 v100, v38, v102, v233
  v_fma_f32 v101, v38, v103, v249
  v_fmac_f32 v100, v40, v103
  v_fmac_f32 v101, v39, v102
  v_fma_f32 v102, v38, v100, v234
  v_fma_f32 v103, v38, v101, v250
  v_fmac_f32 v102, v40, v101
  v_fmac_f32 v103, v39, v100
  v_fma_f32 v100, v38, v102, v235
  v_fma_f32 v101, v38, v103, v251
  v_fmac_f32 v100, v40, v103
  v_fmac_f32 v101, v39, v102
  v_fma_f32 v102, v38, v100, v236
  v_fma_f32 v103, v38, v101, v252
  v_fmac_f32 v102, v40, v101
  v_fmac_f32 v103, v39, v100
  v_fma_f32 v100, v38, v102, v237
  v_fma_f32 v101, v38, v103, v253
  v_fmac_f32 v100, v40, v103
  v_fmac_f32 v101, v39, v102
  v_fma_f32 v102, v38, v100, v238
  v_fma_f32 v103, v38, v101, v254
  v_fmac_f32 v102, v40, v101
  v_fmac_f32 v103, v39, v100
  v_fma_f32 v100, v38, v102, v239
  v_fma_f32 v101, v38, v103, v255
  v_fmac_f32 v100, v40, v103
  v_fmac_f32 v101, v39, v102
  ds_write_b64 v52, v[100:101] offset:1792
  v_mfma_f32_32x32x16_bf16 v[112:127], a[128:131], a[8:11], v[112:127]
  s_waitcnt lgkmcnt(0)
  s_barrier
  v_mfma_f32_32x32x16_bf16 v[128:143], a[132:135], a[8:11], v[128:143]
  ds_read_b64_tr_b16 a[128:129], v18 offset:16384
  ds_read_b64_tr_b16 a[130:131], v18 offset:16896
  ds_read_b64_tr_b16 a[132:133], v22 offset:16384
  ds_read_b64_tr_b16 a[134:135], v22 offset:16896
  s_add_u32 m0, s97, 0
  ds_read_b64 v[80:81], v52 offset:0
  buffer_load_dwordx4 v2, s[8:11], s82 offen offset:0 lds
  v_mfma_f32_32x32x16_bf16 v[144:159], a[136:139], a[8:11], v[144:159]
  ds_read_b64_tr_b16 a[136:137], v26 offset:16384
  ds_read_b64_tr_b16 a[138:139], v26 offset:16896
  ds_read_b64 v[82:83], v52 offset:256
  ds_read_b64 v[84:85], v52 offset:512
  ds_read_b64 v[86:87], v52 offset:768
  ds_read_b64 v[88:89], v52 offset:1024
  ds_read_b64 v[90:91], v52 offset:1280
  ds_read_b64 v[92:93], v52 offset:1536
  v_mfma_f32_32x32x16_bf16 v[112:127], a[144:147], a[12:15], v[112:127]
  ds_read_b64_tr_b16 a[144:145], v19 offset:16384
  ds_read_b64_tr_b16 a[146:147], v19 offset:16896
  buffer_load_dwordx4 v3, s[8:11], s82 offen offset:1024 lds
  s_waitcnt lgkmcnt(7)
  v_fma_f32 v82, v43, v80, v82
  v_fma_f32 v83, v43, v81, v83
  v_fma_f32 v82, -v44, v81, v82
  v_fma_f32 v83, v44, v80, v83
  s_waitcnt lgkmcnt(6)
  v_fma_f32 v84, v43, v82, v84
  v_mfma_f32_32x32x16_bf16 v[128:143], a[148:151], a[12:15], v[128:143]
  ds_read_b64_tr_b16 a[148:149], v23 offset:16384
  ds_read_b64_tr_b16 a[150:151], v23 offset:16896
  v_fma_f32 v85, v43, v83, v85
  v_fma_f32 v84, -v44, v83, v84
  v_fma_f32 v85, v44, v82, v85
  s_waitcnt lgkmcnt(7)
  v_fma_f32 v86, v43, v84, v86
  v_fma_f32 v87, v43, v85, v87
  v_fma_f32 v86, -v44, v85, v86
  v_fma_f32 v87, v44, v84, v87
  s_waitcnt lgkmcnt(6)
  v_fma_f32 v88, v43, v86, v88
  v_fma_f32 v89, v43, v87, v89
  v_mfma_f32_32x32x16_bf16 v[144:159], a[152:155], a[12:15], v[144:159]
  ds_read_b64_tr_b16 a[152:153], v27 offset:16384
  ds_read_b64_tr_b16 a[154:155], v27 offset:16896
  buffer_load_dwordx4 v4, s[12:15], s82 offen offset:2048 lds
  v_fma_f32 v88, -v44, v87, v88
  v_fma_f32 v89, v44, v86, v89
  s_waitcnt lgkmcnt(6)
  v_fma_f32 v90, v43, v88, v90
  v_fma_f32 v91, v43, v89, v91
  v_fma_f32 v90, -v44, v89, v90
  v_mfma_f32_32x32x16_bf16 v[112:127], a[128:131], a[16:19], v[112:127]
  s_waitcnt vmcnt(10)
  buffer_store_dword v51, v13, s[24:27], s53 offen offset:0 sc1
  v_fma_f32 v91, v44, v88, v91
  v_fma_f32 v92, v43, v90, v92
  v_fma_f32 v93, v43, v91, v93
  v_fma_f32 v92, -v44, v91, v92
  v_fma_f32 v93, v44, v90, v93
  v_fma_f32 v96, v43, v92, v100
  v_fma_f32 v98, v43, v93, v101
  v_fma_f32 v96, -v44, v93, v96
  v_mfma_f32_16x16x32_bf16 a[176:179], v[104:107], a[128:131], a[176:179]
  ds_read_b64_tr_b16 a[128:129], v20 offset:16384
  ds_read_b64_tr_b16 a[130:131], v20 offset:16896
  v_fma_f32 v98, v44, v92, v98
  v_mov_b32 v97, v51
  v_mfma_f32_32x32x16_bf16 v[128:143], a[132:135], a[16:19], v[128:143]
  buffer_load_dwordx4 v5, s[12:15], s82 offen offset:3072 lds
  s_add_u32 s82, s82, 229376
  s_cmp_eq_u32 s82, s83
  s_cselect_b32 s82, s58, s82
  v_mov_b32 v99, v51
  v_add_u32 v80, 4294966784, v1
  v_mov_b32 v81, 2146435072
  v_mfma_f32_16x16x32_bf16 a[180:183], v[104:107], a[132:135], a[180:183]
  ds_read_b64_tr_b16 a[132:133], v24 offset:16384
  ds_read_b64_tr_b16 a[134:135], v24 offset:16896
  v_cmp_le_u32 vcc, 512, v1
  s_nop 1
  v_cndmask_b32 v80, v81, v80, vcc
  v_mfma_f32_32x32x16_bf16 v[144:159], a[136:139], a[16:19], v[144:159]
  s_cmp_eq_u32 s48, 3
  s_cselect_b32 s70, s101, 2146435072
  buffer_store_dwordx4 v[96:99], v80, s[24:27], s70 offen sc1
  v_mfma_f32_16x16x32_bf16 a[184:187], v[104:107], a[136:139], a[184:187]
  ds_read_b64_tr_b16 a[136:137], v28 offset:16384
  ds_read_b64_tr_b16 a[138:139], v28 offset:16896
  s_waitcnt lgkmcnt(4)
  v_mfma_f32_32x32x16_bf16 v[112:127], a[144:147], a[20:23], v[112:127]
  ds_read_b64_tr_b16 a[144:145], v21 offset:16384
  ds_read_b64_tr_b16 a[146:147], v21 offset:16896
  s_add_u32 m0, s61, 12288
  s_xor_b32 s93, s73, 0
  buffer_load_dwordx4 v7, s[32:35], s93 offen offset:0 lds
  v_bfe_u32 v86, v1, 9, 1
  v_mfma_f32_32x32x16_bf16 v[128:143], a[148:151], a[20:23], v[128:143]
  ds_read_b64_tr_b16 a[148:149], v25 offset:16384
  ds_read_b64_tr_b16 a[150:151], v25 offset:16896
  s_lshl_b32 s70, s48, 1
  v_add_u32 v86, s70, v86
  v_and_b32 v87, 511, v1
  v_lshl_add_u32 v87, v86, 10, v87
  v_lshlrev_b32 v86, 1, v86
  v_add_u32 v86, s49, v86
  v_cmp_le_u32 vcc, 16, v86
  s_nop 1
  v_cndmask_b32 v82, v81, v87, vcc
  v_cndmask_b32 v84, v61, v51, vcc
  v_mfma_f32_32x32x16_bf16 v[144:159], a[152:155], a[20:23], v[144:159]
  ds_read_b64_tr_b16 a[152:153], v29 offset:16384
  ds_read_b64_tr_b16 a[154:155], v29 offset:16896
  buffer_load_dwordx4 v8, s[32:35], s93 offen offset:1024 lds
  v_cmp_le_u32 vcc, 15, v86
  s_nop 1
  v_cndmask_b32 v83, v81, v87, vcc
  v_cndmask_b32 v85, v61, v51, vcc
  s_sub_u32 s101, s101, 8192
  v_mfma_f32_32x32x16_bf16 v[112:127], a[128:131], a[24:27], v[112:127]
  s_nop 0
  v_mul_f32 v76, v42, v224
  v_mul_f32 v224, v41, v224
  v_fma_f32 v224, -v42, v240, v224
  v_fma_f32 v240, v41, v240, v76
  v_mul_f32 v77, v42, v225
  s_waitcnt lgkmcnt(0)
  s_barrier
  v_mfma_f32_32x32x16_bf16 v[128:143], a[132:135], a[24:27], v[128:143]
  ds_read_b64_tr_b16 a[128:129], v18 offset:32768
  ds_read_b64_tr_b16 a[130:131], v18 offset:33280
  ds_read_b64_tr_b16 a[132:133], v22 offset:32768
  ds_read_b64_tr_b16 a[134:135], v22 offset:33280
  buffer_load_dwordx4 v9, s[32:35], s93 offen offset:2048 lds
  v_mfma_f32_32x32x16_bf16 v[144:159], a[136:139], a[24:27], v[144:159]
  ds_read_b64_tr_b16 a[136:137], v26 offset:32768
  ds_read_b64_tr_b16 a[138:139], v26 offset:33280
  buffer_load_dwordx4 v10, s[32:35], s93 offen offset:3072 lds
  v_mul_f32 v225, v41, v225
  v_mfma_f32_32x32x16_bf16 v[112:127], a[144:147], a[28:31], v[112:127]
  ds_read_b64_tr_b16 a[144:145], v19 offset:32768
  s_add_u32 m0, s97, 16384
  ds_read_b64_tr_b16 a[146:147], v19 offset:33280
  buffer_load_dwordx4 v2, s[8:11], s82 offen offset:0 lds
  v_fma_f32 v225, -v42, v241, v225
  v_mfma_f32_32x32x16_bf16 v[128:143], a[148:151], a[28:31], v[128:143]
  ds_read_b64_tr_b16 a[148:149], v23 offset:32768
  ds_read_b64_tr_b16 a[150:151], v23 offset:33280
  buffer_load_dwordx4 v3, s[8:11], s82 offen offset:1024 lds
  v_mfma_f32_32x32x16_bf16 v[144:159], a[152:155], a[28:31], v[144:159]
  ds_read_b64_tr_b16 a[152:153], v27 offset:32768
  ds_read_b64_tr_b16 a[154:155], v27 offset:33280
  v_fma_f32 v241, v41, v241, v77
  v_mul_f32 v76, v42, v226
  v_mul_f32 v226, v41, v226
  v_fma_f32 v226, -v42, v242, v226
  v_fma_f32 v242, v41, v242, v76
  s_waitcnt lgkmcnt(6)
  v_mfma_f32_32x32x16_bf16 v[112:127], a[128:131], a[32:35], v[112:127]
  buffer_load_dwordx4 v4, s[12:15], s82 offen offset:2048 lds
  v_mul_f32 v77, v42, v227
  v_mul_f32 v227, v41, v227
  v_fma_f32 v227, -v42, v243, v227
  v_mfma_f32_16x16x32_bf16 a[176:179], v[104:107], a[128:131], a[176:179]
  ds_read_b64_tr_b16 a[128:129], v20 offset:32768
  ds_read_b64_tr_b16 a[130:131], v20 offset:33280
  v_mfma_f32_32x32x16_bf16 v[128:143], a[132:135], a[32:35], v[128:143]
  buffer_load_dwordx4 v5, s[12:15], s82 offen offset:3072 lds
  s_add_u32 s82, s82, 229376
  s_cmp_eq_u32 s82, s83
  s_cselect_b32 s82, s58, s82
  v_fma_f32 v243, v41, v243, v77
  v_mfma_f32_16x16x32_bf16 a[180:183], v[104:107], a[132:135], a[180:183]
  ds_read_b64_tr_b16 a[132:133], v24 offset:32768
  ds_read_b64_tr_b16 a[134:135], v24 offset:33280
  v_mfma_f32_32x32x16_bf16 v[144:159], a[136:139], a[32:35], v[144:159]
  s_add_u32 m0, s61, 16384
  s_xor_b32 s93, s73, 32768
  buffer_load_dwordx4 v7, s[32:35], s93 offen offset:0 lds
  v_mul_f32 v76, v42, v228
  v_mul_f32 v228, v41, v228
  v_mfma_f32_16x16x32_bf16 a[184:187], v[104:107], a[136:139], a[184:187]
  ds_read_b64_tr_b16 a[136:137], v28 offset:32768
  ds_read_b64_tr_b16 a[138:139], v28 offset:33280
  s_waitcnt lgkmcnt(6)
  v_mfma_f32_32x32x16_bf16 v[112:127], a[144:147], a[36:39], v[112:127]
  ds_read_b64_tr_b16 a[144:145], v21 offset:32768
  ds_read_b64_tr_b16 a[146:147], v21 offset:33280
  buffer_load_dwordx4 v8, s[32:35], s93 offen offset:1024 lds
  v_fma_f32 v228, -v42, v244, v228
  v_mfma_f32_32x32x16_bf16 v[128:143], a[148:151], a[36:39], v[128:143]
  ds_read_b64_tr_b16 a[148:149], v25 offset:32768
  ds_read_b64_tr_b16 a[150:151], v25 offset:33280
  v_fma_f32 v244, v41, v244, v76
  v_mul_f32 v77, v42, v229
  v_mul_f32 v229, v41, v229
  v_fma_f32 v229, -v42, v245, v229
  v_fma_f32 v245, v41, v245, v77
  v_mfma_f32_32x32x16_bf16 v[144:159], a[152:155], a[36:39], v[144:159]
  ds_read_b64_tr_b16 a[152:153], v29 offset:32768
  ds_read_b64_tr_b16 a[154:155], v29 offset:33280
  buffer_load_dwordx4 v9, s[32:35], s93 offen offset:2048 lds
  s_waitcnt lgkmcnt(8)
  v_mfma_f32_32x32x16_bf16 v[112:127], a[128:131], a[40:43], v[112:127]
  s_nop 0
  v_mul_f32 v76, v42, v230
  v_mul_f32 v230, v41, v230
  v_fma_f32 v230, -v42, v246, v230
  v_fma_f32 v246, v41, v246, v76
  v_mul_f32 v77, v42, v231
  s_waitcnt lgkmcnt(0)
  s_barrier
  v_mfma_f32_32x32x16_bf16 v[128:143], a[132:135], a[40:43], v[128:143]
  ds_read_b64_tr_b16 a[128:129], v18 offset:49152
  ds_read_b64_tr_b16 a[130:131], v18 offset:49664
  ds_read_b64_tr_b16 a[132:133], v22 offset:49152
  ds_read_b64_tr_b16 a[134:135], v22 offset:49664
  buffer_load_dwordx4 v10, s[32:35], s93 offen offset:3072 lds
  v_mfma_f32_32x32x16_bf16 v[144:159], a[136:139], a[40:43], v[144:159]
  ds_read_b64_tr_b16 a[136:137], v26 offset:49152
  ds_read_b64_tr_b16 a[138:139], v26 offset:49664
  v_mul_f32 v231, v41, v231
  v_mfma_f32_32x32x16_bf16 v[112:127], a[144:147], a[44:47], v[112:127]
  ds_read_b64_tr_b16 a[144:145], v19 offset:49152
  s_add_u32 m0, s97, 32768
  ds_read_b64_tr_b16 a[146:147], v19 offset:49664
  buffer_load_dwordx4 v2, s[8:11], s82 offen offset:0 lds
  v_mfma_f32_32x32x16_bf16 v[128:143], a[148:151], a[44:47], v[128:143]
  ds_read_b64_tr_b16 a[148:149], v23 offset:49152
  ds_read_b64_tr_b16 a[150:151], v23 offset:49664
  v_fma_f32 v231, -v42, v247, v231
  v_fma_f32 v247, v41, v247, v77
  v_mul_f32 v76, v42, v232
  v_mul_f32 v232, v41, v232
  v_fma_f32 v232, -v42, v248, v232
  v_mfma_f32_32x32x16_bf16 v[144:159], a[152:155], a[44:47], v[144:159]
  ds_read_b64_tr_b16 a[152:153], v27 offset:49152
  ds_read_b64_tr_b16 a[154:155], v27 offset:49664
  buffer_load_dwordx4 v3, s[8:11], s82 offen offset:1024 lds
  s_waitcnt lgkmcnt(6)
  v_mfma_f32_32x32x16_bf16 v[112:127], a[128:131], a[48:51], v[112:127]
  buffer_load_dwordx4 v[96:99], v82, s[24:27], s101 offen sc1
  s_sub_u32 s68, s97, s61
  v_fma_f32 v248, v41, v248, v76
  v_mul_f32 v77, v42, v233
  v_mul_f32 v233, v41, v233
  v_mfma_f32_16x16x32_bf16 a[176:179], v[104:107], a[128:131], a[176:179]
  ds_read_b64_tr_b16 a[128:129], v20 offset:49152
  ds_read_b64_tr_b16 a[130:131], v20 offset:49664
  v_fma_f32 v233, -v42, v249, v233
  v_mfma_f32_32x32x16_bf16 v[128:143], a[132:135], a[48:51], v[128:143]
  buffer_load_dwordx4 v[100:103], v83, s[24:27], s101 offen offset:512 sc1
  v_fma_f32 v249, v41, v249, v77
  v_mul_f32 v76, v42, v234
  v_add_u32 v90, s68, v57
  v_add_u32 v91, s68, v58
  v_mfma_f32_16x16x32_bf16 a[180:183], v[104:107], a[132:135], a[180:183]
  ds_read_b64_tr_b16 a[132:133], v24 offset:49152
  ds_read_b64_tr_b16 a[134:135], v24 offset:49664
  v_mfma_f32_32x32x16_bf16 v[144:159], a[136:139], a[48:51], v[144:159]
  buffer_load_dwordx4 v4, s[12:15], s82 offen offset:2048 lds
  v_mfma_f32_16x16x32_bf16 a[184:187], v[104:107], a[136:139], a[184:187]
  ds_read_b64_tr_b16 a[136:137], v28 offset:49152
  ds_read_b64_tr_b16 a[138:139], v28 offset:49664
  s_waitcnt lgkmcnt(6)
  v_mfma_f32_32x32x16_bf16 v[112:127], a[144:147], a[52:55], v[112:127]
  ds_read_b64_tr_b16 a[144:145], v21 offset:49152
  ds_read_b64_tr_b16 a[146:147], v21 offset:49664
  buffer_load_dwordx4 v5, s[12:15], s82 offen offset:3072 lds
  s_add_u32 s82, s82, 229376
  s_cmp_eq_u32 s82, s83
  s_cselect_b32 s82, s58, s82
  v_mfma_f32_32x32x16_bf16 v[128:143], a[148:151], a[52:55], v[128:143]
  ds_read_b64_tr_b16 a[148:149], v25 offset:49152
  ds_read_b64_tr_b16 a[150:151], v25 offset:49664
  v_mul_f32 v234, v41, v234
  v_fma_f32 v234, -v42, v250, v234
  v_fma_f32 v250, v41, v250, v76
  v_mfma_f32_32x32x16_bf16 v[144:159], a[152:155], a[52:55], v[144:159]
  ds_read_b64_tr_b16 a[152:153], v29 offset:49152
  ds_read_b64_tr_b16 a[154:155], v29 offset:49664
  v_mul_f32 v77, v42, v235
  v_mul_f32 v235, v41, v235
  v_fma_f32 v235, -v42, v251, v235
  s_waitcnt lgkmcnt(8)
  v_mfma_f32_32x32x16_bf16 v[112:127], a[128:131], a[56:59], v[112:127]
  s_nop 0
  v_fma_f32 v251, v41, v251, v77
  v_mul_f32 v76, v42, v236
  v_mul_f32 v236, v41, v236
  v_fma_f32 v236, -v42, v252, v236
  v_fma_f32 v252, v41, v252, v76
  s_waitcnt vmcnt(19) lgkmcnt(0)
  s_barrier
  v_mfma_f32_32x32x16_bf16 v[128:143], a[132:135], a[56:59], v[128:143]
  ds_read_b64_tr_b16 a[128:129], v18 offset:0
  ds_read_b64_tr_b16 a[130:131], v18 offset:512
  ds_read_b64_tr_b16 a[132:133], v22 offset:0
  ds_read_b64_tr_b16 a[134:135], v22 offset:512
  buffer_load_dword v59, v54, s[24:27], s59 offen offset:0 sc1
  v_mfma_f32_32x32x16_bf16 v[144:159], a[136:139], a[56:59], v[144:159]
  ds_read_b64_tr_b16 a[136:137], v26 offset:0
  ds_read_b64_tr_b16 a[138:139], v26 offset:512
  v_mul_f32 v77, v42, v237
  v_mfma_f32_32x32x16_bf16 v[112:127], a[144:147], a[60:63], v[112:127]
  ds_read_b64_tr_b16 a[144:145], v19 offset:0
  s_add_u32 m0, s97, 49152
  ds_read_b64_tr_b16 a[146:147], v19 offset:512
  buffer_load_dwordx4 v2, s[8:11], s82 offen offset:0 lds
  v_mul_f32 v237, v41, v237
  v_mfma_f32_32x32x16_bf16 v[128:143], a[148:151], a[60:63], v[128:143]
  ds_read_b64_tr_b16 a[148:149], v23 offset:0
  ds_read_b64_tr_b16 a[150:151], v23 offset:512
  v_fma_f32 v237, -v42, v253, v237
  v_fma_f32 v253, v41, v253, v77
  v_mul_f32 v76, v42, v238
  v_mul_f32 v238, v41, v238
  v_fma_f32 v238, -v42, v254, v238
  v_mfma_f32_32x32x16_bf16 v[144:159], a[152:155], a[60:63], v[144:159]
  ds_read_b64_tr_b16 a[152:153], v27 offset:0
  ds_read_b64_tr_b16 a[154:155], v27 offset:512
  buffer_load_dwordx4 v3, s[8:11], s82 offen offset:1024 lds
  s_waitcnt lgkmcnt(6)
  v_mfma_f32_32x32x16_bf16 v[112:127], a[128:131], a[64:67], v[112:127]
  s_nop 0
  v_fma_f32 v254, v41, v254, v76
  v_mul_f32 v77, v42, v239
  v_mul_f32 v239, v41, v239
  v_fma_f32 v239, -v42, v255, v239
  v_fma_f32 v255, v41, v255, v77
  v_mfma_f32_16x16x32_bf16 a[176:179], v[104:107], a[128:131], a[176:179]
  ds_read_b64_tr_b16 a[128:129], v20 offset:0
  ds_read_b64_tr_b16 a[130:131], v20 offset:512
  v_mfma_f32_32x32x16_bf16 v[128:143], a[132:135], a[64:67], v[128:143]
  buffer_load_dwordx4 v4, s[12:15], s82 offen offset:2048 lds
  v_mfma_f32_16x16x32_bf16 a[180:183], v[104:107], a[132:135], a[180:183]
  ds_read_b64_tr_b16 a[132:133], v24 offset:0
  ds_read_b64_tr_b16 a[134:135], v24 offset:512
  v_mfma_f32_32x32x16_bf16 v[144:159], a[136:139], a[64:67], v[144:159]
  buffer_load_dwordx4 v5, s[12:15], s82 offen offset:3072 lds
  v_mfma_f32_16x16x32_bf16 a[184:187], v[104:107], a[136:139], a[184:187]
  ds_read_b64_tr_b16 a[136:137], v28 offset:0
  ds_read_b64_tr_b16 a[138:139], v28 offset:512
  s_waitcnt lgkmcnt(6)
  v_mfma_f32_32x32x16_bf16 v[112:127], a[144:147], a[68:71], v[112:127]
  ds_read_b64_tr_b16 a[144:145], v21 offset:0
  ds_read_b64_tr_b16 a[146:147], v21 offset:512
  v_mfma_f32_32x32x16_bf16 v[128:143], a[148:151], a[68:71], v[128:143]
  ds_read_b64_tr_b16 a[148:149], v25 offset:0
  ds_read_b64_tr_b16 a[150:151], v25 offset:512
  v_mfma_f32_32x32x16_bf16 v[144:159], a[152:155], a[68:71], v[144:159]
  ds_read_b64_tr_b16 a[152:153], v29 offset:0
  ds_read_b64_tr_b16 a[154:155], v29 offset:512
  s_waitcnt vmcnt(7)
  v_xor_b32 v86, v84, v97
  v_xor_b32 v87, v84, v99
  v_xor_b32 v88, v85, v101
  v_xor_b32 v89, v85, v103
  v_or3_b32 v86, v86, v87, v88
  v_or_b32 v86, v86, v89
  v_cmp_ne_u32 vcc, 0, v86
  s_and_b64 vcc, exec, vcc
  s_cbranch_vccz L_ok3
  s_mov_b32 s71, 30000
L_sp3:
  s_sleep 1
  buffer_load_dwordx4 v[96:99], v82, s[24:27], s101 offen sc1
  buffer_load_dwordx4 v[100:103], v83, s[24:27], s101 offen offset:512 sc1
  s_waitcnt vmcnt(0)
  v_xor_b32 v86, v84, v97
  v_xor_b32 v87, v84, v99
  v_xor_b32 v88, v85, v101
  v_xor_b32 v89, v85, v103
  v_or3_b32 v86, v86, v87, v88
  v_or_b32 v86, v86, v89
  v_cmp_ne_u32 vcc, 0, v86
  s_and_b64 vcc, exec, vcc
  s_cbranch_vccz L_ok3
  s_sub_u32 s71, s71, 1
  s_cmp_lg_u32 s71, 0
  s_cbranch_scc1 L_sp3
L_ok3:
  v_fma_f32 v100, v47, v96, v100
  v_fma_f32 v102, v47, v98, v102
  v_fma_f32 v100, -v48, v98, v100
  v_fma_f32 v102, v48, v96, v102
  v_mul_f32 v86, v49, v100
  v_mul_f32 v87, v49, v102
  v_fma_f32 v86, -v50, v102, v86
  v_fmac_f32 v87, v50, v100
  ds_write_b64 v52, v[86:87] offset:2048
  s_waitcnt lgkmcnt(4)
  v_mfma_f32_32x32x16_bf16 v[112:127], a[128:131], a[72:75], v[112:127]
  s_waitcnt lgkmcnt(0)
  s_barrier
  v_mfma_f32_32x32x16_bf16 v[128:143], a[132:135], a[72:75], v[128:143]
  ds_read_b64_tr_b16 a[128:129], v18 offset:16384
  ds_read_b64_tr_b16 a[130:131], v18 offset:16896
  ds_read_b64_tr_b16 a[132:133], v22 offset:16384
  ds_read_b64_tr_b16 a[134:135], v22 offset:16896
  v_mfma_f32_32x32x16_bf16 v[144:159], a[136:139], a[72:75], v[144:159]
  ds_read_b64_tr_b16 a[136:137], v26 offset:16384
  ds_read_b64_tr_b16 a[138:139], v26 offset:16896
  ds_read_b64 v[72:73], v53 offset:2048
  ds_read_b64 v[74:75], v53 offset:2304
  ds_read_b64 v[76:77], v53 offset:2560
  ds_read_b64 v[96:97], v53 offset:2816
  ds_read_b64 v[98:99], v53 offset:3072
  ds_read_b64 v[100:101], v53 offset:3328
  ds_read_b64 v[102:103], v53 offset:3584
  ds_read_b64 v[86:87], v53 offset:3840
  v_mfma_f32_32x32x16_bf16 v[112:127], a[144:147], a[76:79], v[112:127]
  ds_read_b64_tr_b16 a[144:145], v19 offset:16384
  s_waitcnt lgkmcnt(14)
  ds_read_b64_tr_b16 a[146:147], v19 offset:16896
  s_lshr_b32 s92, s55, 1
  s_xor_b32 s92, s92, 0
  s_mul_i32 s92, s92, 49152
  s_add_u32 m0, s97, 0
  s_add_u32 s92, s92, s56
  buffer_load_dwordx4 v11, s[36:39], s92 offen offset:0 lds
  s_waitcnt lgkmcnt(5)
  v_add_f32 v72, v72, v98
  v_add_f32 v73, v73, v99
  s_waitcnt lgkmcnt(4)
  v_add_f32 v74, v74, v100
  v_add_f32 v75, v75, v101
  s_waitcnt lgkmcnt(3)
  v_add_f32 v76, v76, v102
  v_add_f32 v77, v77, v103
  s_waitcnt lgkmcnt(2)
  v_add_f32 v96, v96, v86
  v_add_f32 v97, v97, v87
  v_add_f32 v72, v72, v76
  v_add_f32 v73, v73, v77
  v_add_f32 v74, v74, v96
  v_add_f32 v75, v75, v97
  v_add_f32 v72, v72, v74
  v_mfma_f32_32x32x16_bf16 v[128:143], a[148:151], a[76:79], v[128:143]
  ds_read_b64_tr_b16 a[148:149], v23 offset:16384
  ds_read_b64_tr_b16 a[150:151], v23 offset:16896
  v_add_f32 v73, v73, v75
  v_fma_f32 v88, v45, v72, v92
  v_fma_f32 v89, v45, v73, v93
  v_fma_f32 v88, -v46, v73, v88
  v_fma_f32 v89, v46, v72, v89
  v_mul_f32 v78, v41, v88
  v_mul_f32 v79, v41, v89
  v_fma_f32 v78, -v42, v89, v78
  v_fmac_f32 v79, v42, v88
  v_fmac_f32 v224, v38, v78
  v_fmac_f32 v240, v38, v79
  v_fmac_f32 v224, v40, v79
  v_fmac_f32 v240, v39, v78
  v_fmac_f32 v225, v38, v224
  v_fmac_f32 v241, v38, v240
  v_fmac_f32 v225, v40, v240
  v_fmac_f32 v241, v39, v224
  v_fmac_f32 v226, v38, v225
  v_fmac_f32 v242, v38, v241
  v_fmac_f32 v226, v40, v241
  v_fmac_f32 v242, v39, v225
  v_mfma_f32_32x32x16_bf16 v[144:159], a[152:155], a[76:79], v[144:159]
  ds_read_b64_tr_b16 a[152:153], v27 offset:16384
  ds_read_b64_tr_b16 a[154:155], v27 offset:16896
  buffer_load_dwordx4 v12, s[36:39], s92 offen offset:1024 lds
  v_fmac_f32 v227, v38, v226
  v_fmac_f32 v243, v38, v242
  v_fmac_f32 v227, v40, v242
  v_fmac_f32 v243, v39, v226
  v_cvt_pk_bf16_f32 v96, v224, v225
  v_cvt_pk_bf16_f32 v80, -v240, -v241
  v_fmac_f32 v228, v38, v227
  v_fmac_f32 v244, v38, v243
  v_fmac_f32 v228, v40, v243
  v_fmac_f32 v244, v39, v227
  v_fmac_f32 v229, v38, v228
  v_fmac_f32 v245, v38, v244
  v_fmac_f32 v229, v40, v244
  v_fmac_f32 v245, v39, v228
  v_cvt_pk_bf16_f32 v97, v226, v227
  v_cvt_pk_bf16_f32 v81, -v242, -v243
  v_fmac_f32 v230, v38, v229
  v_mfma_f32_32x32x16_bf16 v[112:127], a[128:131], a[80:83], v[112:127]
  s_nop 0
  v_fmac_f32 v246, v38, v245
  v_fmac_f32 v230, v40, v245
  v_fmac_f32 v246, v39, v229
  v_fmac_f32 v231, v38, v230
  v_fmac_f32 v247, v38, v246
  v_fmac_f32 v231, v40, v246
  v_fmac_f32 v247, v39, v230
  v_cvt_pk_bf16_f32 v98, v228, v229
  v_cvt_pk_bf16_f32 v82, -v244, -v245
  v_fmac_f32 v232, v38, v231
  v_fmac_f32 v248, v38, v247
  v_fmac_f32 v232, v40, v247
  v_fmac_f32 v248, v39, v231
  v_fmac_f32 v233, v38, v232
  v_fmac_f32 v249, v38, v248
  v_fmac_f32 v233, v40, v248
  v_fmac_f32 v249, v39, v232
  v_mfma_f32_16x16x32_bf16 a[176:179], v[104:107], a[128:131], a[176:179]
  ds_read_b64_tr_b16 a[128:129], v20 offset:16384
  ds_read_b64_tr_b16 a[130:131], v20 offset:16896
  v_cvt_pk_bf16_f32 v99, v230, v231
  v_cvt_pk_bf16_f32 v83, -v246, -v247
  v_fmac_f32 v234, v38, v233
  v_fmac_f32 v250, v38, v249
  v_mfma_f32_32x32x16_bf16 v[128:143], a[132:135], a[80:83], v[128:143]
  buffer_load_dwordx4 v32, s[36:39], s92 offen offset:2048 lds
  v_fmac_f32 v234, v40, v249
  v_fmac_f32 v250, v39, v233
  v_fmac_f32 v235, v38, v234
  v_fmac_f32 v251, v38, v250
  v_fmac_f32 v235, v40, v250
  v_fmac_f32 v251, v39, v234
  v_cvt_pk_bf16_f32 v100, v232, v233
  v_cvt_pk_bf16_f32 v84, -v248, -v249
  v_fmac_f32 v236, v38, v235
  v_fmac_f32 v252, v38, v251
  v_fmac_f32 v236, v40, v251
  v_fmac_f32 v252, v39, v235
  v_mfma_f32_16x16x32_bf16 a[180:183], v[104:107], a[132:135], a[180:183]
  ds_read_b64_tr_b16 a[132:133], v24 offset:16384
  ds_read_b64_tr_b16 a[134:135], v24 offset:16896
  v_fmac_f32 v237, v38, v236
  v_fmac_f32 v253, v38, v252
  v_fmac_f32 v237, v40, v252
  v_fmac_f32 v253, v39, v236
  v_mfma_f32_32x32x16_bf16 v[144:159], a[136:139], a[80:83], v[144:159]
  buffer_load_dwordx4 v33, s[36:39], s92 offen offset:3072 lds
  v_cvt_pk_bf16_f32 v101, v234, v235
  v_cvt_pk_bf16_f32 v85, -v250, -v251
  v_fmac_f32 v238, v38, v237
  v_fmac_f32 v254, v38, v253
  v_fmac_f32 v238, v40, v253
  v_fmac_f32 v254, v39, v237
  v_fmac_f32 v239, v38, v238
  v_fmac_f32 v255, v38, v254
  v_fmac_f32 v239, v40, v254
  v_fmac_f32 v255, v39, v238
  v_cvt_pk_bf16_f32 v102, v236, v237
  v_cvt_pk_bf16_f32 v86, -v252, -v253
  v_mfma_f32_16x16x32_bf16 a[184:187], v[104:107], a[136:139], a[184:187]
  ds_read_b64_tr_b16 a[136:137], v28 offset:16384
  ds_read_b64_tr_b16 a[138:139], v28 offset:16896
  v_cvt_pk_bf16_f32 v103, v238, v239
  v_cvt_pk_bf16_f32 v87, -v254, -v255
  s_waitcnt vmcnt(8)
  v_cmp_ne_u32 vcc, v51, v59
  s_and_b64 vcc, exec, vcc
  s_cbranch_vccz L_ok5
  s_mov_b32 s71, 30000
L_sp5:
  s_sleep 1
  buffer_load_dword v59, v54, s[24:27], s59 offen offset:0 sc1
  s_waitcnt vmcnt(0)
  v_cmp_ne_u32 vcc, v51, v59
  s_and_b64 vcc, exec, vcc
  s_cbranch_vccz L_ok5
  s_sub_u32 s71, s71, 1
  s_cmp_lg_u32 s71, 0
  s_cbranch_scc1 L_sp5
L_ok5:
  s_waitcnt lgkmcnt(3)
  v_mfma_f32_32x32x16_bf16 v[112:127], a[144:147], a[84:87], v[112:127]
  ds_read_b64_tr_b16 a[144:145], v21 offset:16384
  ds_read_b64_tr_b16 a[146:147], v21 offset:16896
  ds_write_b128 v14, v[96:99] offset:0
  ds_write_b128 v15, v[100:103] offset:0
  s_and_b32 s96, s55, 4
  s_lshl_b32 s96, s96, 12
  s_and_b32 s65, s55, 3
  s_lshl_b32 s65, s65, 10
  s_add_u32 s96, s96, s65
  s_add_u32 s96, s96, s64
  s_xor_b32 s96, s96, 524288
  s_xor_b32 s65, s96, 0
  buffer_load_dwordx4 a[0:3], v1, s[24:27], s65 offen offset:0 sc1
  v_mfma_f32_32x32x16_bf16 v[128:143], a[148:151], a[84:87], v[128:143]
  ds_read_b64_tr_b16 a[148:149], v25 offset:16384
  ds_read_b64_tr_b16 a[150:151], v25 offset:16896
  s_xor_b32 s94, s96, 262144
  buffer_load_dwordx4 a[4:7], v1, s[24:27], s94 offen offset:0 sc1
  v_bfe_u32 v2, v1, 7, 3
  v_lshlrev_b32 v2, 10, v2
  v_and_b32 v3, 0x70, v1
  v_add_u32 v2, v2, v3
  v_lshrrev_b32 v3, 2, v1
  v_add_u32 v4, 7168, v2
  v_mfma_f32_32x32x16_bf16 v[144:159], a[152:155], a[84:87], v[144:159]
  ds_read_b64_tr_b16 a[152:153], v29 offset:16384
  ds_read_b64_tr_b16 a[154:155], v29 offset:16896
  s_lshl_b32 s69, s51, 6
  s_lshl_b32 s83, s48, 4
  s_add_u32 s69, s69, s83
  s_lshl_b32 s58, s69, 10
  s_add_u32 s58, s58, s72
  s_lshl_b32 s69, s69, 4
  s_add_u32 s69, s69, 262144
  s_lshl_b32 s83, s48, 8
  s_xor_b32 s65, s96, 1024
  buffer_load_dwordx4 a[8:11], v1, s[24:27], s65 offen offset:0 sc1
  v_mfma_f32_32x32x16_bf16 v[112:127], a[128:131], a[88:91], v[112:127]
  s_xor_b32 s94, s96, 263168
  buffer_load_dwordx4 a[12:15], v1, s[24:27], s94 offen offset:0 sc1
  s_waitcnt lgkmcnt(0)
  s_barrier
  v_mfma_f32_32x32x16_bf16 v[128:143], a[132:135], a[88:91], v[128:143]
  ds_read_b64_tr_b16 a[128:129], v18 offset:32768
  ds_read_b64_tr_b16 a[130:131], v18 offset:33280
  ds_read_b64_tr_b16 a[132:133], v22 offset:32768
  ds_read_b64_tr_b16 a[134:135], v22 offset:33280
  ds_write_b128 v14, v[80:83] offset:2048
  s_add_u32 m0, s61, 20480
  ds_write_b128 v15, v[84:87] offset:2048
  buffer_load_dwordx4 v2, s[4:7], s58 offen offset:0 lds
  v_mfma_f32_32x32x16_bf16 v[144:159], a[136:139], a[88:91], v[144:159]
  ds_read_b64_tr_b16 a[136:137], v26 offset:32768
  ds_read_b64_tr_b16 a[138:139], v26 offset:33280
  buffer_load_dwordx4 v4, s[4:7], s58 offen offset:1024 lds
  v_mfma_f32_32x32x16_bf16 v[112:127], a[144:147], a[92:95], v[112:127]
  ds_read_b64_tr_b16 a[144:145], v19 offset:32768
  s_add_u32 m0, s83, 161792
  ds_read_b64_tr_b16 a[146:147], v19 offset:33280
  buffer_load_dword v3, s[24:27], s69 offen sc1 lds
  s_lshl_b32 s58, s58, 1
  ds_read_b64_tr_b16 v[224:225], v16 offset:0
  ds_read_b64_tr_b16 v[226:227], v17 offset:256
  v_mfma_f32_32x32x16_bf16 v[128:143], a[148:151], a[92:95], v[128:143]
  ds_read_b64_tr_b16 a[148:149], v23 offset:32768
  ds_read_b64_tr_b16 a[150:151], v23 offset:33280
  ds_read_b64_tr_b16 v[228:229], v16 offset:1024
  s_waitcnt lgkmcnt(13)
  ds_read_b64_tr_b16 v[230:231], v17 offset:1280
  ds_read_b64_tr_b16 v[232:233], v16 offset:2048
  s_xor_b32 s65, s96, 2048
  buffer_load_dwordx4 a[16:19], v1, s[24:27], s65 offen offset:0 sc1
  v_mfma_f32_32x32x16_bf16 v[144:159], a[152:155], a[92:95], v[144:159]
  s_waitcnt lgkmcnt(11)
  ds_read_b64_tr_b16 a[152:153], v27 offset:32768
  ds_read_b64_tr_b16 a[154:155], v27 offset:33280
  ds_read_b64_tr_b16 v[234:235], v17 offset:2304
  ds_read_b64_tr_b16 v[236:237], v16 offset:3072
  s_waitcnt lgkmcnt(14)
  ds_read_b64_tr_b16 v[238:239], v17 offset:3328
  s_xor_b32 s94, s96, 264192
  buffer_load_dwordx4 a[20:23], v1, s[24:27], s94 offen offset:0 sc1
  v_mfma_f32_32x32x16_bf16 v[112:127], a[128:131], a[96:99], v[112:127]
  s_add_u32 s70, s62, 4096
  s_waitcnt lgkmcnt(10)
  buffer_store_dwordx4 v[224:227], v1, s[24:27], s70 offen offset:0 sc1
  v_mfma_f32_16x16x32_bf16 a[176:179], v[104:107], a[128:131], a[176:179]
  ds_read_b64_tr_b16 a[128:129], v20 offset:32768
  ds_read_b64_tr_b16 a[130:131], v20 offset:33280
  v_mfma_f32_32x32x16_bf16 v[128:143], a[132:135], a[96:99], v[128:143]
  s_add_u32 s70, s62, 4096
  s_waitcnt lgkmcnt(8)
  buffer_store_dwordx4 v[228:231], v1, s[24:27], s70 offen offset:1024 sc1
  v_mfma_f32_16x16x32_bf16 a[180:183], v[104:107], a[132:135], a[180:183]
  ds_read_b64_tr_b16 a[132:133], v24 offset:32768
  ds_read_b64_tr_b16 a[134:135], v24 offset:33280
  v_mfma_f32_32x32x16_bf16 v[144:159], a[136:139], a[96:99], v[144:159]
  s_add_u32 s70, s62, 4096
  s_waitcnt lgkmcnt(4)
  buffer_store_dwordx4 v[232:235], v1, s[24:27], s70 offen offset:2048 sc1
  v_mfma_f32_16x16x32_bf16 a[184:187], v[104:107], a[136:139], a[184:187]
  ds_read_b64_tr_b16 a[136:137], v28 offset:32768
  ds_read_b64_tr_b16 a[138:139], v28 offset:33280
  v_mfma_f32_32x32x16_bf16 v[112:127], a[144:147], a[100:103], v[112:127]
  ds_read_b64_tr_b16 a[144:145], v21 offset:32768
  ds_read_b64_tr_b16 a[146:147], v21 offset:33280
  s_add_u32 s70, s62, 4096
  buffer_store_dwordx4 v[236:239], v1, s[24:27], s70 offen offset:3072 sc1
  v_mfma_f32_32x32x16_bf16 v[128:143], a[148:151], a[100:103], v[128:143]
  ds_read_b64_tr_b16 a[148:149], v25 offset:32768
  ds_read_b64_tr_b16 a[150:151], v25 offset:33280
  s_xor_b32 s65, s96, 3072
  buffer_load_dwordx4 a[24:27], v1, s[24:27], s65 offen offset:0 sc1
  v_mfma_f32_32x32x16_bf16 v[144:159], a[152:155], a[100:103], v[144:159]
  ds_read_b64_tr_b16 a[152:153], v29 offset:32768
  ds_read_b64_tr_b16 a[154:155], v29 offset:33280
  s_xor_b32 s94, s96, 265216
  buffer_load_dwordx4 a[28:31], v1, s[24:27], s94 offen offset:0 sc1
  s_waitcnt lgkmcnt(8)
  v_mfma_f32_32x32x16_bf16 v[112:127], a[128:131], a[104:107], v[112:127]
  s_xor_b32 s65, s96, 16384
  buffer_load_dwordx4 a[32:35], v1, s[24:27], s65 offen offset:0 sc1
  v_bfe_u32 v30, v1, 6, 1
  v_lshlrev_b32 v30, 7, v30
  v_bfe_u32 v31, v1, 5, 1
  v_lshl_add_u32 v30, v31, 4, v30
  v_bfe_u32 v31, v1, 4, 1
  s_waitcnt vmcnt(20)
  s_barrier
  v_mfma_f32_32x32x16_bf16 v[128:143], a[132:135], a[104:107], v[128:143]
  ds_read_b64_tr_b16 a[128:129], v18 offset:49152
  ds_read_b64_tr_b16 a[130:131], v18 offset:49664
  ds_read_b64_tr_b16 a[132:133], v22 offset:49152
  ds_read_b64_tr_b16 a[134:135], v22 offset:49664
  s_xor_b32 s94, s96, 278528
  buffer_load_dwordx4 a[36:39], v1, s[24:27], s94 offen offset:0 sc1
  s_waitcnt lgkmcnt(6)
  v_mfma_f32_32x32x16_bf16 v[144:159], a[136:139], a[104:107], v[144:159]
  ds_read_b64_tr_b16 a[136:137], v26 offset:49152
  ds_read_b64_tr_b16 a[138:139], v26 offset:49664
  v_lshl_add_u32 v30, v31, 2, v30
  s_and_b32 s57, s51, 1
  s_mul_i32 s57, s57, 120
  s_sub_u32 s57, 128, s57
  v_add_u32 v30, s57, v30
  v_mfma_f32_32x32x16_bf16 v[112:127], a[144:147], a[108:111], v[112:127]
  ds_read_b64_tr_b16 a[144:145], v19 offset:49152
  ds_read_b64_tr_b16 a[146:147], v19 offset:49664
  s_xor_b32 s65, s96, 17408
  buffer_load_dwordx4 a[40:43], v1, s[24:27], s65 offen offset:0 sc1
  v_mfma_f32_32x32x16_bf16 v[128:143], a[148:151], a[108:111], v[128:143]
  ds_read_b64_tr_b16 a[148:149], v23 offset:49152
  ds_read_b64_tr_b16 a[150:151], v23 offset:49664
  s_waitcnt lgkmcnt(6)
  v_mfma_f32_32x32x16_bf16 v[144:159], a[152:155], a[108:111], v[144:159]
  ds_read_b64_tr_b16 a[152:153], v27 offset:49152
  ds_read_b64_tr_b16 a[154:155], v27 offset:49664
  s_xor_b32 s94, s96, 279552
  buffer_load_dwordx4 a[44:47], v1, s[24:27], s94 offen offset:0 sc1
  v_mfma_f32_32x32x16_bf16 v[112:127], a[128:131], a[112:115], v[112:127]
  s_waitcnt vmcnt(6)
  buffer_store_dword v51, v13, s[24:27], s53 offen offset:1024 sc1
  v_mfma_f32_16x16x32_bf16 a[176:179], v[104:107], a[128:131], a[176:179]
  ds_read_b64_tr_b16 a[128:129], v20 offset:49152
  ds_read_b64_tr_b16 a[130:131], v20 offset:49664
  v_mfma_f32_32x32x16_bf16 v[128:143], a[132:135], a[112:115], v[128:143]
  s_lshr_b32 s92, s55, 1
  s_xor_b32 s92, s92, 0
  s_mul_i32 s92, s92, 49152
  s_add_u32 s92, s92, s56
  s_add_u32 m0, s97, 16384
  s_add_u32 s92, s92, 32768
  buffer_load_dwordx4 v11, s[36:39], s92 offen offset:0 lds
  v_mfma_f32_16x16x32_bf16 a[180:183], v[104:107], a[132:135], a[180:183]
  ds_read_b64_tr_b16 a[132:133], v24 offset:49152
  ds_read_b64_tr_b16 a[134:135], v24 offset:49664
  s_waitcnt lgkmcnt(4)
  v_mfma_f32_32x32x16_bf16 v[144:159], a[136:139], a[112:115], v[144:159]
  buffer_load_dwordx4 v12, s[36:39], s92 offen offset:1024 lds
  v_mfma_f32_16x16x32_bf16 a[184:187], v[104:107], a[136:139], a[184:187]
  ds_read_b64_tr_b16 a[136:137], v28 offset:49152
  ds_read_b64_tr_b16 a[138:139], v28 offset:49664
  v_mfma_f32_32x32x16_bf16 v[112:127], a[144:147], a[116:119], v[112:127]
  ds_read_b64_tr_b16 a[144:145], v21 offset:49152
  ds_read_b64_tr_b16 a[146:147], v21 offset:49664
  ds_write2st64_b32 v110, a176, a177 offset0:16 offset1:17
  ds_write2st64_b32 v110, a180, a181 offset0:18 offset1:19
  s_nop 4
  ds_write2st64_b32 v110, a184, a185 offset0:20 offset1:21
  s_lshr_b32 s92, s55, 1
  s_xor_b32 s92, s92, 1
  s_mul_i32 s92, s92, 49152
  s_add_u32 m0, s97, 18432
  s_add_u32 s92, s92, s56
  buffer_load_dwordx4 v11, s[36:39], s92 offen offset:0 lds
  v_mfma_f32_32x32x16_bf16 v[128:143], a[148:151], a[116:119], v[128:143]
  ds_read_b64_tr_b16 a[148:149], v25 offset:49152
  ds_read_b64_tr_b16 a[150:151], v25 offset:49664
  v_mfma_f32_32x32x16_bf16 v[144:159], a[152:155], a[116:119], v[144:159]
  ds_read_b64_tr_b16 a[152:153], v29 offset:49152
  ds_read_b64_tr_b16 a[154:155], v29 offset:49664
  buffer_load_dwordx4 v12, s[36:39], s92 offen offset:1024 lds
  s_waitcnt lgkmcnt(9)
  v_mfma_f32_32x32x16_bf16 v[112:127], a[128:131], a[120:123], v[112:127]
  s_waitcnt lgkmcnt(4)
  s_barrier
  v_mfma_f32_32x32x16_bf16 v[128:143], a[132:135], a[120:123], v[128:143]
  v_mfma_f32_32x32x16_bf16 v[144:159], a[136:139], a[120:123], v[144:159]
  v_mfma_f32_32x32x16_bf16 v[112:127], a[144:147], a[124:127], v[112:127]
  ds_read_b128 v[72:75], v111 offset:4096
  ds_read_b128 v[76:79], v111 offset:4608
  s_waitcnt lgkmcnt(1)
  v_add_f32 v72, v72, v73
  s_waitcnt lgkmcnt(0)
  v_add_f32 v76, v76, v77
  v_add_f32 v74, v74, v75
  v_mfma_f32_32x32x16_bf16 v[128:143], a[148:151], a[124:127], v[128:143]
  s_nop 0
  v_add_f32 v78, v78, v79
  v_add_f32 v72, v72, v74
  v_add_f32 v76, v76, v78
  v_and_b32 v73, 0xffff0000, v72
  v_and_b32 v77, 0xffff0000, v76
  v_sub_f32 v72, v72, v73
  v_mfma_f32_32x32x16_bf16 v[144:159], a[152:155], a[124:127], v[144:159]
  s_nop 0
  v_sub_f32 v76, v76, v77
  v_cvt_pk_bf16_f32 v64, v73, v72
  v_cvt_pk_bf16_f32 v68, v77, v76
  s_nop 0
  v_mfma_f32_32x32x16_bf16 v[112:127], v[64:67], v[60:63], v[112:127]
  ds_read_b128 v[72:75], v111 offset:5120
  ds_read_b128 a[64:67], v34 offset:4096
  s_waitcnt lgkmcnt(1)
  v_add_f32 v72, v72, v73
  v_add_f32 v74, v74, v75
  v_add_f32 v72, v72, v74
  v_mfma_f32_32x32x16_bf16 v[128:143], v[68:71], v[60:63], v[128:143]
  ds_read_b128 a[68:71], v34 offset:8192
  v_and_b32 v73, 0xffff0000, v72
  v_sub_f32 v72, v72, v73
  v_cvt_pk_bf16_f32 v64, v73, v72
  v_mfma_f32_32x32x16_bf16 a[128:143], a[192:195], a[0:3], 0
  v_mfma_f32_32x32x16_bf16 a[144:159], a[192:195], a[4:7], 0
  v_mfma_f32_32x32x16_bf16 a[160:175], a[196:199], a[0:3], 0
  s_xor_b32 s65, s96, 18432
  buffer_load_dwordx4 a[0:3], v1, s[24:27], s65 offen offset:0 sc1
  v_mfma_f32_32x32x16_bf16 a[176:191], a[196:199], a[4:7], 0
  s_xor_b32 s94, s96, 280576
  buffer_load_dwordx4 a[4:7], v1, s[24:27], s94 offen offset:0 sc1
  v_mfma_f32_32x32x16_bf16 v[144:159], v[64:67], v[60:63], v[144:159]
  ds_read_b128 a[72:75], v35 offset:4096
  ds_read_b128 a[76:79], v35 offset:8192
  v_mfma_f32_32x32x16_bf16 a[128:143], a[200:203], a[8:11], a[128:143]
  v_mfma_f32_32x32x16_bf16 a[144:159], a[200:203], a[12:15], a[144:159]
  v_mfma_f32_32x32x16_bf16 a[160:175], a[204:207], a[8:11], a[160:175]
  s_xor_b32 s65, s96, 19456
  buffer_load_dwordx4 a[8:11], v1, s[24:27], s65 offen offset:0 sc1
  v_mfma_f32_32x32x16_bf16 a[176:191], a[204:207], a[12:15], a[176:191]
  s_xor_b32 s94, s96, 281600
  buffer_load_dwordx4 a[12:15], v1, s[24:27], s94 offen offset:0 sc1
  v_mfma_f32_32x32x16_bf16 a[128:143], a[208:211], a[16:19], a[128:143]
  ds_read_b128 a[80:83], v36 offset:4096
  ds_read_b128 a[84:87], v36 offset:8192
  v_mul_f32 v112, v55, v112
  v_mul_f32 v113, v55, v113
  v_mul_f32 v114, v55, v114
  v_mul_f32 v115, v55, v115
  v_mul_f32 v116, v55, v116
  v_mul_f32 v117, v55, v117
  v_mul_f32 v118, v55, v118
  v_mul_f32 v119, v55, v119
  v_exp_f32 v112, v112
  v_exp_f32 v113, v113
  v_exp_f32 v114, v114
  v_exp_f32 v115, v115
  v_exp_f32 v116, v116
  v_mfma_f32_32x32x16_bf16 a[144:159], a[208:211], a[20:23], a[144:159]
  s_nop 0
  v_exp_f32 v117, v117
  v_exp_f32 v118, v118
  v_exp_f32 v119, v119
  v_fma_f32 v112, v112, v56, v56
  v_fma_f32 v113, v113, v56, v56
  v_fma_f32 v114, v114, v56, v56
  v_fma_f32 v115, v115, v56, v56
  v_fma_f32 v116, v116, v56, v56
  v_fma_f32 v117, v117, v56, v56
  v_fma_f32 v118, v118, v56, v56
  v_fma_f32 v119, v119, v56, v56
  v_rcp_f32 v112, v112
  v_rcp_f32 v113, v113
  v_rcp_f32 v114, v114
  v_rcp_f32 v115, v115
  v_mfma_f32_32x32x16_bf16 a[160:175], a[212:215], a[16:19], a[160:175]
  s_and_b32 s96, s55, 4
  s_lshl_b32 s96, s96, 12
  s_and_b32 s65, s55, 3
  s_lshl_b32 s65, s65, 10
  s_add_u32 s96, s96, s65
  s_add_u32 s96, s96, s64
  s_xor_b32 s65, s96, 0
  buffer_load_dwordx4 a[16:19], v1, s[24:27], s65 offen offset:0 sc1
  v_rcp_f32 v116, v116
  v_rcp_f32 v117, v117
  v_rcp_f32 v118, v118
  v_rcp_f32 v119, v119
  v_mul_f32 v112, v112, v120
  v_mfma_f32_32x32x16_bf16 a[176:191], a[212:215], a[20:23], a[176:191]
  s_xor_b32 s94, s96, 262144
  buffer_load_dwordx4 a[20:23], v1, s[24:27], s94 offen offset:0 sc1
  v_mul_f32 v113, v113, v121
  v_mul_f32 v114, v114, v122
  v_mul_f32 v115, v115, v123
  v_mul_f32 v116, v116, v124
  v_mul_f32 v117, v117, v125
  v_mul_f32 v118, v118, v126
  v_mul_f32 v119, v119, v127
  v_cvt_pk_bf16_f32 v120, v112, v113
  v_cvt_pk_bf16_f32 v121, v114, v115
  v_cvt_pk_bf16_f32 v122, v116, v117
  v_cvt_pk_bf16_f32 v123, v118, v119
  s_waitcnt vmcnt(16)
  v_mfma_f32_32x32x16_bf16 a[128:143], a[216:219], a[24:27], a[128:143]
  s_add_u32 s70, s62, 8192
  buffer_store_dwordx4 v[120:123], v1, s[24:27], s70 offen offset:0 sc1
  ds_read_b128 a[88:91], v37 offset:4096
  ds_read_b128 a[92:95], v37 offset:8192
  v_mul_f32 v128, v55, v128
  v_mul_f32 v129, v55, v129
  v_mul_f32 v130, v55, v130
  v_mul_f32 v131, v55, v131
  v_mul_f32 v132, v55, v132
  v_mul_f32 v133, v55, v133
  v_mul_f32 v134, v55, v134
  v_mul_f32 v135, v55, v135
  v_exp_f32 v128, v128
  v_exp_f32 v129, v129
  s_waitcnt vmcnt(16)
  v_mfma_f32_32x32x16_bf16 a[144:159], a[216:219], a[28:31], a[144:159]
  s_nop 0
  v_exp_f32 v130, v130
  v_exp_f32 v131, v131
  v_exp_f32 v132, v132
  v_exp_f32 v133, v133
  v_exp_f32 v134, v134
  v_exp_f32 v135, v135
  v_fma_f32 v128, v128, v56, v56
  v_fma_f32 v129, v129, v56, v56
  v_fma_f32 v130, v130, v56, v56
  v_fma_f32 v131, v131, v56, v56
  v_fma_f32 v132, v132, v56, v56
  v_fma_f32 v133, v133, v56, v56
  v_fma_f32 v134, v134, v56, v56
  v_fma_f32 v135, v135, v56, v56
  v_rcp_f32 v128, v128
  v_mfma_f32_32x32x16_bf16 a[160:175], a[220:223], a[24:27], a[160:175]
  s_xor_b32 s65, s96, 1024
  buffer_load_dwordx4 a[24:27], v1, s[24:27], s65 offen offset:0 sc1
  v_rcp_f32 v129, v129
  v_rcp_f32 v130, v130
  v_rcp_f32 v131, v131
  v_rcp_f32 v132, v132
  v_rcp_f32 v133, v133
  v_rcp_f32 v134, v134
  v_rcp_f32 v135, v135
  v_mul_f32 v128, v128, v136
  v_mfma_f32_32x32x16_bf16 a[176:191], a[220:223], a[28:31], a[176:191]
  s_xor_b32 s94, s96, 263168
  buffer_load_dwordx4 a[28:31], v1, s[24:27], s94 offen offset:0 sc1
  v_mul_f32 v129, v129, v137
  v_mul_f32 v130, v130, v138
  v_mul_f32 v131, v131, v139
  v_mul_f32 v132, v132, v140
  v_mul_f32 v133, v133, v141
  v_mul_f32 v134, v134, v142
  v_mul_f32 v135, v135, v143
  v_cvt_pk_bf16_f32 v136, v128, v129
  v_cvt_pk_bf16_f32 v137, v130, v131
  v_cvt_pk_bf16_f32 v138, v132, v133
  v_cvt_pk_bf16_f32 v139, v134, v135
  s_waitcnt vmcnt(17)
  v_mfma_f32_32x32x16_bf16 a[128:143], a[224:227], a[32:35], a[128:143]
  s_add_u32 s70, s62, 8192
  buffer_store_dwordx4 v[136:139], v1, s[24:27], s70 offen offset:1024 sc1
  ds_read_b128 a[96:99], v34 offset:12288
  ds_read_b128 a[100:103], v34 offset:16384
  v_mul_f32 v144, v55, v144
  v_mul_f32 v145, v55, v145
  v_mul_f32 v146, v55, v146
  v_mul_f32 v147, v55, v147
  v_mul_f32 v148, v55, v148
  v_mul_f32 v149, v55, v149
  v_mul_f32 v150, v55, v150
  v_mul_f32 v151, v55, v151
  v_exp_f32 v144, v144
  v_exp_f32 v145, v145
  s_waitcnt vmcnt(17)
  v_mfma_f32_32x32x16_bf16 a[144:159], a[224:227], a[36:39], a[144:159]
  s_nop 0
  v_exp_f32 v146, v146
  v_exp_f32 v147, v147
  v_exp_f32 v148, v148
  v_exp_f32 v149, v149
  v_exp_f32 v150, v150
  v_exp_f32 v151, v151
  v_fma_f32 v144, v144, v56, v56
  v_fma_f32 v145, v145, v56, v56
  v_fma_f32 v146, v146, v56, v56
  v_fma_f32 v147, v147, v56, v56
  v_fma_f32 v148, v148, v56, v56
  v_fma_f32 v149, v149, v56, v56
  v_fma_f32 v150, v150, v56, v56
  v_fma_f32 v151, v151, v56, v56
  v_rcp_f32 v144, v144
  v_mfma_f32_32x32x16_bf16 a[160:175], a[228:231], a[32:35], a[160:175]
  s_xor_b32 s65, s96, 2048
  buffer_load_dwordx4 a[32:35], v1, s[24:27], s65 offen offset:0 sc1
  v_rcp_f32 v145, v145
  v_rcp_f32 v146, v146
  v_rcp_f32 v147, v147
  v_rcp_f32 v148, v148
  v_rcp_f32 v149, v149
  v_rcp_f32 v150, v150
  v_rcp_f32 v151, v151
  v_mul_f32 v144, v144, v152
  v_mfma_f32_32x32x16_bf16 a[176:191], a[228:231], a[36:39], a[176:191]
  s_xor_b32 s94, s96, 264192
  buffer_load_dwordx4 a[36:39], v1, s[24:27], s94 offen offset:0 sc1
  v_mul_f32 v145, v145, v153
  v_mul_f32 v146, v146, v154
  v_mul_f32 v147, v147, v155
  v_mul_f32 v148, v148, v156
  v_mul_f32 v149, v149, v157
  v_mul_f32 v150, v150, v158
  v_mul_f32 v151, v151, v159
  v_cvt_pk_bf16_f32 v152, v144, v145
  v_cvt_pk_bf16_f32 v153, v146, v147
  v_cvt_pk_bf16_f32 v154, v148, v149
  v_cvt_pk_bf16_f32 v155, v150, v151
  s_waitcnt vmcnt(18)
  v_mfma_f32_32x32x16_bf16 a[128:143], a[232:235], a[40:43], a[128:143]
  s_add_u32 s70, s62, 8192
  buffer_store_dwordx4 v[152:155], v1, s[24:27], s70 offen offset:2048 sc1
  ds_read_b128 a[104:107], v35 offset:12288
  ds_read_b128 a[108:111], v35 offset:16384
  s_waitcnt vmcnt(18)
  v_mfma_f32_32x32x16_bf16 a[144:159], a[232:235], a[44:47], a[144:159]
  s_lshr_b32 s92, s55, 1
  s_xor_b32 s92, s92, 1
  s_mul_i32 s92, s92, 49152
  s_add_u32 s92, s92, s56
  s_add_u32 m0, s61, 4096
  s_add_u32 s92, s92, 16384
  buffer_load_dwordx4 v11, s[36:39], s92 offen offset:0 lds
  v_mfma_f32_32x32x16_bf16 a[160:175], a[236:239], a[40:43], a[160:175]
  s_xor_b32 s65, s96, 3072
  buffer_load_dwordx4 a[40:43], v1, s[24:27], s65 offen offset:0 sc1
  v_mfma_f32_32x32x16_bf16 a[176:191], a[236:239], a[44:47], a[176:191]
  s_xor_b32 s94, s96, 265216
  buffer_load_dwordx4 a[44:47], v1, s[24:27], s94 offen offset:0 sc1
  s_waitcnt vmcnt(15)
  v_mfma_f32_32x32x16_bf16 a[128:143], a[240:243], a[0:3], a[128:143]
  ds_read_b128 a[112:115], v36 offset:12288
  ds_read_b128 a[116:119], v36 offset:16384
  buffer_load_dwordx4 v12, s[36:39], s92 offen offset:1024 lds
  s_waitcnt vmcnt(15)
  v_mfma_f32_32x32x16_bf16 a[144:159], a[240:243], a[4:7], a[144:159]
  s_lshr_b32 s92, s55, 1
  s_xor_b32 s92, s92, 1
  s_mul_i32 s92, s92, 49152
  s_add_u32 s92, s92, s56
  s_add_u32 m0, s61, 6144
  s_add_u32 s92, s92, 32768
  buffer_load_dwordx4 v11, s[36:39], s92 offen offset:0 lds
  v_mfma_f32_32x32x16_bf16 a[160:175], a[244:247], a[0:3], a[160:175]
  s_xor_b32 s65, s96, 16384
  buffer_load_dwordx4 a[0:3], v1, s[24:27], s65 offen offset:0 sc1
  v_mfma_f32_32x32x16_bf16 a[176:191], a[244:247], a[4:7], a[176:191]
  s_xor_b32 s94, s96, 278528
  buffer_load_dwordx4 a[4:7], v1, s[24:27], s94 offen offset:0 sc1
  s_waitcnt vmcnt(17)
  v_mfma_f32_32x32x16_bf16 a[128:143], a[248:251], a[8:11], a[128:143]
  buffer_load_dword v59, v54, s[24:27], s59 offen offset:1024 sc1
  s_waitcnt vmcnt(17)
  v_mfma_f32_32x32x16_bf16 a[144:159], a[248:251], a[12:15], a[144:159]
  v_mfma_f32_32x32x16_bf16 a[160:175], a[252:255], a[8:11], a[160:175]
  s_xor_b32 s65, s96, 17408
  buffer_load_dwordx4 a[8:11], v1, s[24:27], s65 offen offset:0 sc1
  ds_read_b128 a[120:123], v37 offset:12288
  s_waitcnt lgkmcnt(1)
  ds_read_b128 a[124:127], v37 offset:16384
  v_mfma_f32_32x32x16_bf16 a[176:191], a[252:255], a[12:15], a[176:191]
  s_xor_b32 s94, s96, 279552
  buffer_load_dwordx4 a[12:15], v1, s[24:27], s94 offen offset:0 sc1
  s_waitcnt vmcnt(18)
  v_mfma_f32_32x32x16_bf16 v[160:175], a[192:195], a[16:19], 0
  ds_read_b64_tr_b16 v[224:225], v90 offset:0
  ds_read_b64_tr_b16 v[226:227], v90 offset:512
  ds_read_b64_tr_b16 v[228:229], v91 offset:0
  ds_read_b64_tr_b16 v[230:231], v91 offset:512
  buffer_load_dwordx4 v12, s[36:39], s92 offen offset:1024 lds
  s_waitcnt vmcnt(18)
  v_mfma_f32_32x32x16_bf16 v[176:191], a[192:195], a[20:23], 0
  s_lshr_b32 s92, s55, 1
  s_xor_b32 s92, s92, 2
  s_mul_i32 s92, s92, 49152
  s_add_u32 m0, s61, 8192
  s_add_u32 s92, s92, s56
  buffer_load_dwordx4 v11, s[36:39], s92 offen offset:0 lds
  v_mfma_f32_32x32x16_bf16 v[192:207], a[196:199], a[16:19], 0
  s_xor_b32 s65, s96, 18432
  buffer_load_dwordx4 a[16:19], v1, s[24:27], s65 offen offset:0 sc1
  v_mfma_f32_32x32x16_bf16 v[208:223], a[196:199], a[20:23], 0
  s_xor_b32 s94, s96, 280576
  buffer_load_dwordx4 a[20:23], v1, s[24:27], s94 offen offset:0 sc1
  s_waitcnt vmcnt(19)
  v_mfma_f32_32x32x16_bf16 v[160:175], a[200:203], a[24:27], v[160:175]
  ds_read_b64_tr_b16 v[232:233], v90 offset:2048
  ds_read_b64_tr_b16 v[234:235], v90 offset:2560
  ds_read_b64_tr_b16 v[236:237], v91 offset:2048
  ds_read_b64_tr_b16 v[238:239], v91 offset:2560
  s_waitcnt vmcnt(14)
  buffer_store_dword v51, v13, s[24:27], s53 offen offset:2048 sc1
  v_mfma_f32_32x32x16_bf16 v[176:191], a[200:203], a[28:31], v[176:191]
  buffer_load_dwordx4 v12, s[36:39], s92 offen offset:1024 lds
  v_mfma_f32_32x32x16_bf16 v[192:207], a[204:207], a[24:27], v[192:207]
  s_xor_b32 s65, s96, 19456
  buffer_load_dwordx4 a[24:27], v1, s[24:27], s65 offen offset:0 sc1
  v_mfma_f32_32x32x16_bf16 v[208:223], a[204:207], a[28:31], v[208:223]
  s_xor_b32 s94, s96, 281600
  buffer_load_dwordx4 a[28:31], v1, s[24:27], s94 offen offset:0 sc1
  v_mfma_f32_32x32x16_bf16 v[160:175], a[208:211], a[32:35], v[160:175]
  s_nop 0
  s_waitcnt vmcnt(10)
  v_cmp_ne_u32 vcc, v51, v59
  s_and_b64 vcc, exec, vcc
  s_cbranch_vccz L_ok6
  s_mov_b32 s71, 30000
L_sp6:
  s_sleep 1
  buffer_load_dword v59, v54, s[24:27], s59 offen offset:1024 sc1
  s_waitcnt vmcnt(0)
  v_cmp_ne_u32 vcc, v51, v59
  s_and_b64 vcc, exec, vcc
  s_cbranch_vccz L_ok6
  s_sub_u32 s71, s71, 1
  s_cmp_lg_u32 s71, 0
  s_cbranch_scc1 L_sp6
L_ok6:
  v_mfma_f32_32x32x16_bf16 v[176:191], a[208:211], a[36:39], v[176:191]
  buffer_load_dwordx4 v32, s[36:39], s92 offen offset:2048 lds
  v_mfma_f32_32x32x16_bf16 v[192:207], a[212:215], a[32:35], v[192:207]
  s_and_b32 s96, s55, 4
  s_lshl_b32 s96, s96, 12
  s_and_b32 s65, s55, 1
  s_lshl_b32 s65, s65, 11
  s_add_u32 s96, s96, s65
  s_and_b32 s65, s55, 2
  s_lshl_b32 s65, s65, 9
  s_add_u32 s96, s96, s65
  s_add_u32 s96, s96, s64
  s_xor_b32 s96, s96, 524288
  s_xor_b32 s65, s96, 4096
  buffer_load_dwordx4 a[32:35], v1, s[24:27], s65 offen offset:0 sc1
  ds_read_b64_tr_b16 v[240:241], v90 offset:16384
  ds_read_b64_tr_b16 v[242:243], v90 offset:16896
  ds_read_b64_tr_b16 v[244:245], v91 offset:16384
  ds_read_b64_tr_b16 v[246:247], v91 offset:16896
  v_lshrrev_b32 v73, 8, v1
  v_bfe_u32 v74, v1, 4, 4
  v_lshlrev_b32 v75, 11, v73
  v_lshl_add_u32 v72, v74, 4, v75
  v_mfma_f32_32x32x16_bf16 v[208:223], a[212:215], a[36:39], v[208:223]
  s_xor_b32 s94, s96, 266240
  buffer_load_dwordx4 a[36:39], v1, s[24:27], s94 offen offset:0 sc1
  v_lshlrev_b32 v75, 7, v73
  v_lshl_add_u32 v75, v74, 3, v75
  v_add_u32 v75, s61, v75
  v_lshl_add_u32 v73, v73, 4, s83
  v_add_u32 v73, 161792, v73
  ds_read_b128 v[136:139], v73 offset:0
  s_waitcnt lgkmcnt(5)
  ds_read_b128 v[140:143], v73 offset:64
  ds_read_b128 v[144:147], v73 offset:128
  ds_read_b128 v[148:151], v73 offset:192
  ds_read_b64 v[128:129], v75 offset:20480
  ds_read_b64 v[130:131], v75 offset:20992
  ds_read_b64 v[132:133], v75 offset:21504
  ds_read_b64 v[134:135], v75 offset:22016
  v_mfma_f32_32x32x16_bf16 v[160:175], a[216:219], a[40:43], v[160:175]
  ds_read_b64_tr_b16 v[248:249], v90 offset:18432
  ds_read_b64_tr_b16 v[250:251], v90 offset:18944
  ds_read_b64_tr_b16 v[252:253], v91 offset:18432
  s_waitcnt lgkmcnt(14)
  ds_read_b64_tr_b16 v[254:255], v91 offset:18944
  buffer_load_dwordx4 v33, s[36:39], s92 offen offset:3072 lds
  v_lshlrev_b32 v152, 16, v108
  v_mfma_f32_32x32x16_bf16 v[176:191], a[216:219], a[44:47], v[176:191]
  s_lshr_b32 s92, s55, 1
  s_xor_b32 s92, s92, 3
  s_mul_i32 s92, s92, 49152
  s_add_u32 m0, s61, 12288
  s_add_u32 s92, s92, s56
  buffer_load_dwordx4 v11, s[36:39], s92 offen offset:0 lds
  v_and_b32 v153, 0xffff0000, v108
  v_lshlrev_b32 v154, 16, v109
  v_mfma_f32_32x32x16_bf16 v[192:207], a[220:223], a[40:43], v[192:207]
  s_xor_b32 s65, s96, 5120
  buffer_load_dwordx4 a[40:43], v1, s[24:27], s65 offen offset:0 sc1
  v_and_b32 v155, 0xffff0000, v109
  s_waitcnt lgkmcnt(9)
  v_rcp_f32 v138, v138
  v_rcp_f32 v142, v142
  v_mfma_f32_32x32x16_bf16 v[208:223], a[220:223], a[44:47], v[208:223]
  s_xor_b32 s94, s96, 267264
  buffer_load_dwordx4 a[44:47], v1, s[24:27], s94 offen offset:0 sc1
  v_rcp_f32 v146, v146
  s_waitcnt lgkmcnt(1)
  v_rcp_f32 v150, v150
  v_lshlrev_b32 v112, 16, v128
  v_and_b32 v113, 0xffff0000, v128
  v_mfma_f32_32x32x16_bf16 v[160:175], a[224:227], a[0:3], v[160:175]
  buffer_load_dwordx4 v12, s[36:39], s92 offen offset:1024 lds
  v_sub_f32 v156, v112, v136
  v_sub_f32 v157, v113, v136
  v_cvt_pk_bf16_f32 v158, v156, v157
  v_mfma_f32_32x32x16_bf16 v[176:191], a[224:227], a[4:7], v[176:191]
  buffer_load_dwordx4 v32, s[36:39], s92 offen offset:2048 lds
  v_lshlrev_b32 v156, 16, v158
  v_and_b32 v157, 0xffff0000, v158
  v_mul_f32 v156, v156, v138
  v_mul_f32 v157, v157, v138
  v_mfma_f32_32x32x16_bf16 v[192:207], a[228:231], a[0:3], v[192:207]
  s_xor_b32 s65, s96, 20480
  buffer_load_dwordx4 a[0:3], v1, s[24:27], s65 offen offset:0 sc1
  v_cvt_pk_bf16_f32 v158, v156, v157
  v_lshlrev_b32 v156, 16, v158
  v_and_b32 v157, 0xffff0000, v158
  v_mfma_f32_32x32x16_bf16 v[208:223], a[228:231], a[4:7], v[208:223]
  s_xor_b32 s94, s96, 282624
  buffer_load_dwordx4 a[4:7], v1, s[24:27], s94 offen offset:0 sc1
  v_fmac_f32 v112, v156, v152
  v_fmac_f32 v113, v157, v153
  v_lshlrev_b32 v114, 16, v129
  v_and_b32 v115, 0xffff0000, v129
  s_waitcnt vmcnt(20)
  v_mfma_f32_32x32x16_bf16 v[160:175], a[232:235], a[8:11], v[160:175]
  buffer_load_dwordx4 v33, s[36:39], s92 offen offset:3072 lds
  v_sub_f32 v156, v114, v136
  v_sub_f32 v157, v115, v136
  s_waitcnt vmcnt(20)
  v_mfma_f32_32x32x16_bf16 v[176:191], a[232:235], a[12:15], v[176:191]
  s_nop 0
  v_cvt_pk_bf16_f32 v158, v156, v157
  v_lshlrev_b32 v156, 16, v158
  v_and_b32 v157, 0xffff0000, v158
  v_mul_f32 v156, v156, v138
  v_mul_f32 v157, v157, v138
  v_cvt_pk_bf16_f32 v158, v156, v157
  v_lshlrev_b32 v156, 16, v158
  v_and_b32 v157, 0xffff0000, v158
  v_mfma_f32_32x32x16_bf16 v[192:207], a[236:239], a[8:11], v[192:207]
  s_xor_b32 s65, s96, 21504
  buffer_load_dwordx4 a[8:11], v1, s[24:27], s65 offen offset:0 sc1
  v_fmac_f32 v114, v156, v154
  v_fmac_f32 v115, v157, v155
  v_mfma_f32_32x32x16_bf16 v[208:223], a[236:239], a[12:15], v[208:223]
  s_xor_b32 s94, s96, 283648
  buffer_load_dwordx4 a[12:15], v1, s[24:27], s94 offen offset:0 sc1
  v_lshlrev_b32 v116, 16, v130
  v_and_b32 v117, 0xffff0000, v130
  s_waitcnt vmcnt(19)
  v_mfma_f32_32x32x16_bf16 v[160:175], a[240:243], a[16:19], v[160:175]
  s_lshr_b32 s92, s55, 1
  s_xor_b32 s92, s92, 3
  s_mul_i32 s92, s92, 49152
  s_add_u32 s92, s92, s56
  s_add_u32 m0, s61, 16384
  s_add_u32 s92, s92, 32768
  buffer_load_dwordx4 v11, s[36:39], s92 offen offset:0 lds
  s_waitcnt vmcnt(19)
  v_mfma_f32_32x32x16_bf16 v[176:191], a[240:243], a[20:23], v[176:191]
  buffer_load_dwordx4 v12, s[36:39], s92 offen offset:1024 lds
  v_sub_f32 v156, v116, v140
  v_sub_f32 v157, v117, v140
  v_cvt_pk_bf16_f32 v158, v156, v157
  v_lshlrev_b32 v156, 16, v158
  v_and_b32 v157, 0xffff0000, v158
  v_mul_f32 v156, v156, v142
  v_mfma_f32_32x32x16_bf16 v[192:207], a[244:247], a[16:19], v[192:207]
  s_xor_b32 s65, s96, 6144
  buffer_load_dwordx4 a[16:19], v1, s[24:27], s65 offen offset:0 sc1
  v_mul_f32 v157, v157, v142
  v_cvt_pk_bf16_f32 v158, v156, v157
  v_lshlrev_b32 v156, 16, v158
  v_and_b32 v157, 0xffff0000, v158
  v_mfma_f32_32x32x16_bf16 v[208:223], a[244:247], a[20:23], v[208:223]
  s_xor_b32 s94, s96, 268288
  buffer_load_dwordx4 a[20:23], v1, s[24:27], s94 offen offset:0 sc1
  v_fmac_f32 v116, v156, v152
  v_fmac_f32 v117, v157, v153
  v_lshlrev_b32 v118, 16, v131
  v_and_b32 v119, 0xffff0000, v131
  s_waitcnt vmcnt(19)
  v_mfma_f32_32x32x16_bf16 v[160:175], a[248:251], a[24:27], v[160:175]
  s_lshr_b32 s92, s55, 1
  s_xor_b32 s92, s92, 2
  s_mul_i32 s92, s92, 49152
  s_add_u32 s92, s92, s56
  s_add_u32 m0, s61, 18432
  s_add_u32 s92, s92, 32768
  buffer_load_dwordx4 v11, s[36:39], s92 offen offset:0 lds
  s_waitcnt vmcnt(19)
  v_mfma_f32_32x32x16_bf16 v[176:191], a[248:251], a[28:31], v[176:191]
  buffer_load_dwordx4 v12, s[36:39], s92 offen offset:1024 lds
  v_sub_f32 v156, v118, v140
  v_sub_f32 v157, v119, v140
  v_cvt_pk_bf16_f32 v158, v156, v157
  v_lshlrev_b32 v156, 16, v158
  v_and_b32 v157, 0xffff0000, v158
  v_mul_f32 v156, v156, v142
  v_mfma_f32_32x32x16_bf16 v[192:207], a[252:255], a[24:27], v[192:207]
  s_xor_b32 s65, s96, 7168
  buffer_load_dwordx4 a[24:27], v1, s[24:27], s65 offen offset:0 sc1
  v_mul_f32 v157, v157, v142
  v_cvt_pk_bf16_f32 v158, v156, v157
  v_lshlrev_b32 v156, 16, v158
  v_mfma_f32_32x32x16_bf16 v[208:223], a[252:255], a[28:31], v[208:223]
  s_xor_b32 s94, s96, 269312
  buffer_load_dwordx4 a[28:31], v1, s[24:27], s94 offen offset:0 sc1
  v_and_b32 v157, 0xffff0000, v158
  v_fmac_f32 v118, v156, v154
  v_fmac_f32 v119, v157, v155
  v_lshlrev_b32 v120, 16, v132
  s_waitcnt vmcnt(20)
  v_mfma_f32_32x32x16_bf16 a[128:143], a[64:67], a[32:35], a[128:143]
  s_nop 0
  v_and_b32 v121, 0xffff0000, v132
  v_sub_f32 v156, v120, v144
  v_sub_f32 v157, v121, v144
  v_cvt_pk_bf16_f32 v158, v156, v157
  v_lshlrev_b32 v156, 16, v158
  v_and_b32 v157, 0xffff0000, v158
  s_waitcnt vmcnt(19)
  v_mfma_f32_32x32x16_bf16 a[144:159], a[64:67], a[36:39], a[144:159]
  s_nop 0
  v_mul_f32 v156, v156, v146
  v_mul_f32 v157, v157, v146
  v_cvt_pk_bf16_f32 v158, v156, v157
  v_lshlrev_b32 v156, 16, v158
  v_and_b32 v157, 0xffff0000, v158
  v_fmac_f32 v120, v156, v152
  v_fmac_f32 v121, v157, v153
  v_mfma_f32_32x32x16_bf16 a[160:175], a[68:71], a[32:35], a[160:175]
  s_xor_b32 s65, s96, 22528
  buffer_load_dwordx4 a[32:35], v1, s[24:27], s65 offen offset:0 sc1
  v_mfma_f32_32x32x16_bf16 a[176:191], a[68:71], a[36:39], a[176:191]
  s_xor_b32 s94, s96, 284672
  buffer_load_dwordx4 a[36:39], v1, s[24:27], s94 offen offset:0 sc1
  v_lshlrev_b32 v122, 16, v133
  s_waitcnt vmcnt(18)
  v_mfma_f32_32x32x16_bf16 a[128:143], a[72:75], a[40:43], a[128:143]
  s_nop 0
  v_and_b32 v123, 0xffff0000, v133
  v_sub_f32 v156, v122, v144
  v_sub_f32 v157, v123, v144
  v_cvt_pk_bf16_f32 v158, v156, v157
  v_lshlrev_b32 v156, 16, v158
  v_and_b32 v157, 0xffff0000, v158
  s_waitcnt vmcnt(17)
  v_mfma_f32_32x32x16_bf16 a[144:159], a[72:75], a[44:47], a[144:159]
  s_nop 0
  v_mul_f32 v156, v156, v146
  v_mul_f32 v157, v157, v146
  v_cvt_pk_bf16_f32 v158, v156, v157
  v_lshlrev_b32 v156, 16, v158
  v_and_b32 v157, 0xffff0000, v158
  v_fmac_f32 v122, v156, v154
  v_fmac_f32 v123, v157, v155
  v_mfma_f32_32x32x16_bf16 a[160:175], a[76:79], a[40:43], a[160:175]
  s_xor_b32 s65, s96, 23552
  buffer_load_dwordx4 a[40:43], v1, s[24:27], s65 offen offset:0 sc1
  v_mfma_f32_32x32x16_bf16 a[176:191], a[76:79], a[44:47], a[176:191]
  s_xor_b32 s94, s96, 285696
  buffer_load_dwordx4 a[44:47], v1, s[24:27], s94 offen offset:0 sc1
  v_lshlrev_b32 v124, 16, v134
  s_waitcnt vmcnt(16)
  v_mfma_f32_32x32x16_bf16 a[128:143], a[80:83], a[0:3], a[128:143]
  s_lshr_b32 s99, s51, 1
  s_lshl_b32 s99, s99, 3
  s_add_u32 s99, s99, s52
  s_lshl_b32 s99, s99, 1
  s_and_b32 s98, s51, 1
  s_add_u32 s99, s99, s98
  s_lshl_b32 s98, s99, 14
  s_add_u32 s98, s98, s97
  s_add_u32 s98, s98, 18874368
  s_lshl_b32 s99, s99, 5
  s_add_u32 s99, s99, s48
  s_lshl_b32 s99, s99, 2
  s_add_u32 s99, s99, 327680
  s_waitcnt vmcnt(15)
  v_mfma_f32_32x32x16_bf16 a[144:159], a[80:83], a[4:7], a[144:159]
  s_xor_b32 s82, s98, 16384
  v_and_b32 v125, 0xffff0000, v134
  v_sub_f32 v156, v124, v148
  v_sub_f32 v157, v125, v148
  v_cvt_pk_bf16_f32 v158, v156, v157
  v_lshlrev_b32 v156, 16, v158
  v_and_b32 v157, 0xffff0000, v158
  v_mul_f32 v156, v156, v150
  v_mul_f32 v157, v157, v150
  v_cvt_pk_bf16_f32 v158, v156, v157
  v_lshlrev_b32 v156, 16, v158
  v_and_b32 v157, 0xffff0000, v158
  v_fmac_f32 v124, v156, v152
  v_mfma_f32_32x32x16_bf16 a[160:175], a[84:87], a[0:3], a[160:175]
  s_and_b32 s96, s55, 4
  s_lshl_b32 s96, s96, 12
  s_and_b32 s65, s55, 1
  s_lshl_b32 s65, s65, 11
  s_add_u32 s96, s96, s65
  s_and_b32 s65, s55, 2
  s_lshl_b32 s65, s65, 9
  s_add_u32 s96, s96, s65
  s_add_u32 s96, s96, s64
  s_xor_b32 s65, s96, 4096
  buffer_load_dwordx4 a[0:3], v1, s[24:27], s65 offen offset:0 sc1
  v_mfma_f32_32x32x16_bf16 a[176:191], a[84:87], a[4:7], a[176:191]
  s_xor_b32 s94, s96, 266240
  buffer_load_dwordx4 a[4:7], v1, s[24:27], s94 offen offset:0 sc1
  v_fmac_f32 v125, v157, v153
  v_lshlrev_b32 v126, 16, v135
  s_waitcnt vmcnt(15)
  v_mfma_f32_32x32x16_bf16 a[128:143], a[88:91], a[8:11], a[128:143]
  s_nop 0
  v_and_b32 v127, 0xffff0000, v135
  v_sub_f32 v156, v126, v148
  v_sub_f32 v157, v127, v148
  v_cvt_pk_bf16_f32 v158, v156, v157
  v_lshlrev_b32 v156, 16, v158
  v_and_b32 v157, 0xffff0000, v158
  s_waitcnt vmcnt(14)
  v_mfma_f32_32x32x16_bf16 a[144:159], a[88:91], a[12:15], a[144:159]
  s_nop 0
  v_mul_f32 v156, v156, v150
  v_mul_f32 v157, v157, v150
  v_cvt_pk_bf16_f32 v158, v156, v157
  v_lshlrev_b32 v156, 16, v158
  v_and_b32 v157, 0xffff0000, v158
  v_fmac_f32 v126, v156, v154
  v_mfma_f32_32x32x16_bf16 a[160:175], a[92:95], a[8:11], a[160:175]
  s_xor_b32 s65, s96, 5120
  buffer_load_dwordx4 a[8:11], v1, s[24:27], s65 offen offset:0 sc1
  v_fmac_f32 v127, v157, v155
  v_mfma_f32_32x32x16_bf16 a[176:191], a[92:95], a[12:15], a[176:191]
  s_xor_b32 s94, s96, 267264
  buffer_load_dwordx4 a[12:15], v1, s[24:27], s94 offen offset:0 sc1
  s_waitcnt vmcnt(13)
  v_mfma_f32_32x32x16_bf16 a[128:143], a[96:99], a[16:19], a[128:143]
  s_nop 0
  v_bfe_u32 v81, v1, 6, 1
  v_bfe_u32 v82, v1, 7, 2
  v_lshlrev_b32 v81, 4, v81
  v_lshl_add_u32 v81, v82, 2, v81
  v_bfe_u32 v82, v1, 4, 2
  v_add_u32 v81, v81, v82
  v_lshlrev_b32 v81, 8, v81
  v_bfe_u32 v82, v1, 4, 3
  v_bfe_u32 v83, v1, 9, 1
  s_waitcnt vmcnt(12)
  v_mfma_f32_32x32x16_bf16 a[144:159], a[96:99], a[20:23], a[144:159]
  s_nop 0
  v_xor_b32 v82, v82, v83
  v_lshl_add_u32 v81, v82, 4, v81
  v_add_u32 v76, s60, v81
  v_lshrrev_b32 v81, 8, v1
  v_mfma_f32_32x32x16_bf16 a[160:175], a[100:103], a[16:19], a[160:175]
  s_xor_b32 s65, s96, 20480
  buffer_load_dwordx4 a[16:19], v1, s[24:27], s65 offen offset:0 sc1
  s_and_b32 s68, s48, 1
  s_lshl_b32 s68, s68, 2
  v_add_u32 v82, s68, v81
  v_bfe_u32 v83, v1, 4, 4
  v_xor_b32 v82, v82, v83
  v_mfma_f32_32x32x16_bf16 a[176:191], a[100:103], a[20:23], a[176:191]
  s_xor_b32 s94, s96, 282624
  buffer_load_dwordx4 a[20:23], v1, s[24:27], s94 offen offset:0 sc1
  v_lshlrev_b32 v81, 8, v81
  v_lshl_add_u32 v81, v82, 4, v81
  v_add_u32 v77, s97, v81
  v_xor_b32 v78, 32, v76
  v_xor_b32 v79, 64, v76
  v_xor_b32 v80, 96, v76
  s_waitcnt vmcnt(11)
  v_mfma_f32_32x32x16_bf16 a[128:143], a[104:107], a[24:27], a[128:143]
  s_waitcnt vmcnt(10)
  v_mfma_f32_32x32x16_bf16 a[144:159], a[104:107], a[28:31], a[144:159]
  v_mfma_f32_32x32x16_bf16 a[160:175], a[108:111], a[24:27], a[160:175]
  s_xor_b32 s65, s96, 21504
  buffer_load_dwordx4 a[24:27], v1, s[24:27], s65 offen offset:0 sc1
  v_mfma_f32_32x32x16_bf16 a[176:191], a[108:111], a[28:31], a[176:191]
  s_xor_b32 s94, s96, 283648
  buffer_load_dwordx4 a[28:31], v1, s[24:27], s94 offen offset:0 sc1
  s_waitcnt vmcnt(11)
  v_mfma_f32_32x32x16_bf16 a[128:143], a[112:115], a[32:35], a[128:143]
  s_waitcnt vmcnt(10)
  v_mfma_f32_32x32x16_bf16 a[144:159], a[112:115], a[36:39], a[144:159]
  v_mfma_f32_32x32x16_bf16 a[160:175], a[116:119], a[32:35], a[160:175]
  s_xor_b32 s65, s96, 6144
  buffer_load_dwordx4 a[32:35], v1, s[24:27], s65 offen offset:0 sc1
  v_mfma_f32_32x32x16_bf16 a[176:191], a[116:119], a[36:39], a[176:191]
  s_xor_b32 s94, s96, 268288
  buffer_load_dwordx4 a[36:39], v1, s[24:27], s94 offen offset:0 sc1
  s_barrier
  s_waitcnt vmcnt(11)
  v_mfma_f32_32x32x16_bf16 a[128:143], a[120:123], a[40:43], a[128:143]
  buffer_load_dword v59, v30, s[24:27], s59 offen offset:1920 sc1
  s_waitcnt vmcnt(11)
  v_mfma_f32_32x32x16_bf16 a[144:159], a[120:123], a[44:47], a[144:159]
  v_mfma_f32_32x32x16_bf16 a[160:175], a[124:127], a[40:43], a[160:175]
  s_xor_b32 s65, s96, 7168
  buffer_load_dwordx4 a[40:43], v1, s[24:27], s65 offen offset:0 sc1
  v_mfma_f32_32x32x16_bf16 a[176:191], a[124:127], a[44:47], a[176:191]
  s_xor_b32 s94, s96, 269312
  buffer_load_dwordx4 a[44:47], v1, s[24:27], s94 offen offset:0 sc1
  s_waitcnt vmcnt(12)
  v_mfma_f32_32x32x16_bf16 v[160:175], a[64:67], a[0:3], v[160:175]
  s_nop 0
  ds_write_b128 v76, a[128:131] offset:0
  s_waitcnt vmcnt(11)
  v_mfma_f32_32x32x16_bf16 v[176:191], a[64:67], a[4:7], v[176:191]
  ds_write_b128 v78, a[132:135] offset:0
  v_mfma_f32_32x32x16_bf16 v[192:207], a[68:71], a[0:3], v[192:207]
  s_xor_b32 s65, s96, 22528
  buffer_load_dwordx4 a[0:3], v1, s[24:27], s65 offen offset:0 sc1
  ds_write_b128 v79, a[136:139] offset:0
  v_mfma_f32_32x32x16_bf16 v[208:223], a[68:71], a[4:7], v[208:223]
  s_xor_b32 s94, s96, 284672
  buffer_load_dwordx4 a[4:7], v1, s[24:27], s94 offen offset:0 sc1
  ds_write_b128 v80, a[140:143] offset:0
  s_waitcnt vmcnt(12)
  v_mfma_f32_32x32x16_bf16 v[160:175], a[72:75], a[8:11], v[160:175]
  ds_write_b128 v76, a[144:147] offset:8192
  s_waitcnt vmcnt(11)
  v_mfma_f32_32x32x16_bf16 v[176:191], a[72:75], a[12:15], v[176:191]
  ds_write_b128 v78, a[148:151] offset:8192
  v_mfma_f32_32x32x16_bf16 v[192:207], a[76:79], a[8:11], v[192:207]
  s_xor_b32 s65, s96, 23552
  buffer_load_dwordx4 a[8:11], v1, s[24:27], s65 offen offset:0 sc1
  ds_write_b128 v79, a[152:155] offset:8192
  v_mfma_f32_32x32x16_bf16 v[208:223], a[76:79], a[12:15], v[208:223]
  s_xor_b32 s94, s96, 285696
  buffer_load_dwordx4 a[12:15], v1, s[24:27], s94 offen offset:0 sc1
  ds_write_b128 v80, a[156:159] offset:8192
  s_waitcnt vmcnt(12)
  v_mfma_f32_32x32x16_bf16 v[160:175], a[80:83], a[16:19], v[160:175]
  s_nop 0
  s_waitcnt vmcnt(6)
  v_cmp_ne_u32 vcc, v51, v59
  s_and_b64 vcc, exec, vcc
  s_cbranch_vccz L_ok7
  s_mov_b32 s71, 30000
L_sp7:
  s_sleep 1
  buffer_load_dword v59, v30, s[24:27], s59 offen offset:1920 sc1
  s_waitcnt vmcnt(0)
  v_cmp_ne_u32 vcc, v51, v59
  s_and_b64 vcc, exec, vcc
  s_cbranch_vccz L_ok7
  s_sub_u32 s71, s71, 1
  s_cmp_lg_u32 s71, 0
  s_cbranch_scc1 L_sp7
L_ok7:
  v_mfma_f32_32x32x16_bf16 v[176:191], a[80:83], a[20:23], v[176:191]
  v_mfma_f32_32x32x16_bf16 v[192:207], a[84:87], a[16:19], v[192:207]
  s_lshr_b32 s96, s55, 1
  s_lshl_b32 s96, s96, 14
  s_and_b32 s64, s64, 0xffff7fff
  s_add_u32 s96, s96, s64
  s_xor_b32 s65, s96, 8192
  buffer_load_dwordx4 a[16:19], v1, s[24:27], s65 offen offset:0 sc1
  ds_write_b128 v76, a[160:163] offset:128
  v_mfma_f32_32x32x16_bf16 v[208:223], a[84:87], a[20:23], v[208:223]
  s_xor_b32 s94, s96, 270336
  buffer_load_dwordx4 a[20:23], v1, s[24:27], s94 offen offset:0 sc1
  ds_write_b128 v78, a[164:167] offset:128
  ds_write_b128 v79, a[168:171] offset:128
  ds_write_b128 v80, a[172:175] offset:128
  v_mfma_f32_32x32x16_bf16 v[160:175], a[88:91], a[24:27], v[160:175]
  ds_write_b128 v76, a[176:179] offset:8320
  v_mfma_f32_32x32x16_bf16 v[176:191], a[88:91], a[28:31], v[176:191]
  ds_write_b128 v78, a[180:183] offset:8320
  v_mfma_f32_32x32x16_bf16 v[192:207], a[92:95], a[24:27], v[192:207]
  buffer_load_dwordx4 a[24:27], v1, s[24:27], s65 offen offset:1024 sc1
  s_waitcnt lgkmcnt(6)
  ds_write_b128 v79, a[184:187] offset:8320
  v_mfma_f32_32x32x16_bf16 v[208:223], a[92:95], a[28:31], v[208:223]
  buffer_load_dwordx4 a[28:31], v1, s[24:27], s94 offen offset:1024 sc1
  ds_write_b128 v80, a[188:191] offset:8320
  v_mfma_f32_32x32x16_bf16 v[160:175], a[96:99], a[32:35], v[160:175]
  v_mfma_f32_32x32x16_bf16 v[176:191], a[96:99], a[36:39], v[176:191]
  v_mfma_f32_32x32x16_bf16 v[192:207], a[100:103], a[32:35], v[192:207]
  buffer_load_dwordx4 a[32:35], v1, s[24:27], s65 offen offset:2048 sc1
  v_mfma_f32_32x32x16_bf16 v[208:223], a[100:103], a[36:39], v[208:223]
  buffer_load_dwordx4 a[36:39], v1, s[24:27], s94 offen offset:2048 sc1
  s_waitcnt lgkmcnt(0)
  s_barrier
  s_waitcnt vmcnt(11)
  v_mfma_f32_32x32x16_bf16 v[160:175], a[104:107], a[40:43], v[160:175]
  ds_read_b128 v[128:131], v77 offset:0
  ds_read_b128 v[132:135], v77 offset:16384
  s_waitcnt vmcnt(10)
  v_mfma_f32_32x32x16_bf16 v[176:191], a[104:107], a[44:47], v[176:191]
  ds_read_b128 v[136:139], v77 offset:32768
  ds_read_b128 v[140:143], v77 offset:49152
  v_mfma_f32_32x32x16_bf16 v[192:207], a[108:111], a[40:43], v[192:207]
  s_xor_b32 s65, s96, 24576
  buffer_load_dwordx4 a[40:43], v1, s[24:27], s65 offen offset:0 sc1
  ds_read_b128 v[144:147], v77 offset:1024
  ds_read_b128 v[148:151], v77 offset:17408
  v_mfma_f32_32x32x16_bf16 v[208:223], a[108:111], a[44:47], v[208:223]
  s_xor_b32 s94, s96, 286720
  buffer_load_dwordx4 a[44:47], v1, s[24:27], s94 offen offset:0 sc1
  ds_read_b128 v[152:155], v77 offset:33792
  ds_read_b128 v[156:159], v77 offset:50176
  s_waitcnt vmcnt(11)
  v_mfma_f32_32x32x16_bf16 v[160:175], a[112:115], a[0:3], v[160:175]
  ds_read_b128 v[84:87], v77 offset:2048
  ds_read_b128 v[88:91], v77 offset:18432
  ds_read_b128 v[92:95], v77 offset:34816
  s_waitcnt lgkmcnt(9)
  v_add_f32 v128, v128, v132
  v_add_f32 v129, v129, v133
  v_add_f32 v130, v130, v134
  v_add_f32 v131, v131, v135
  s_waitcnt lgkmcnt(7)
  v_add_f32 v136, v136, v140
  v_add_f32 v137, v137, v141
  v_add_f32 v138, v138, v142
  s_waitcnt vmcnt(10)
  v_mfma_f32_32x32x16_bf16 v[176:191], a[112:115], a[4:7], v[176:191]
  ds_read_b128 v[96:99], v77 offset:51200
  ds_read_b128 v[14:17], v77 offset:3072
  ds_read_b128 v[18:21], v77 offset:19456
  v_add_f32 v139, v139, v143
  v_add_f32 v128, v128, v136
  v_add_f32 v129, v129, v137
  v_add_f32 v130, v130, v138
  v_add_f32 v131, v131, v139
  v_cvt_pk_bf16_f32 v128, v128, v129
  v_cvt_pk_bf16_f32 v130, v130, v131
  v_mfma_f32_32x32x16_bf16 v[192:207], a[116:119], a[0:3], v[192:207]
  buffer_load_dwordx4 a[0:3], v1, s[24:27], s65 offen offset:1024 sc1
  ds_read_b128 v[22:25], v77 offset:35840
  ds_read_b128 v[26:29], v77 offset:52224
  v_mov_b32 v129, v51
  v_mov_b32 v131, v51
  v_mfma_f32_32x32x16_bf16 v[208:223], a[116:119], a[4:7], v[208:223]
  buffer_load_dwordx4 a[4:7], v1, s[24:27], s94 offen offset:1024 sc1
  s_waitcnt vmcnt(11)
  v_mfma_f32_32x32x16_bf16 v[160:175], a[120:123], a[8:11], v[160:175]
  buffer_store_dwordx4 v[128:131], v1, s[24:27], s82 offen offset:0 sc1
  ds_read_b64_tr_b16 a[128:129], v57 offset:4096
  ds_read_b64_tr_b16 a[130:131], v57 offset:4608
  ds_read_b64_tr_b16 a[132:133], v58 offset:4096
  s_waitcnt lgkmcnt(5)
  ds_read_b64_tr_b16 a[134:135], v58 offset:4608
  ds_read_b64_tr_b16 a[136:137], v57 offset:6144
  ds_read_b64_tr_b16 a[138:139], v57 offset:6656
  ds_read_b64_tr_b16 a[140:141], v58 offset:6144
  ds_read_b64_tr_b16 a[142:143], v58 offset:6656
  v_add_f32 v144, v144, v148
  s_waitcnt vmcnt(11)
  v_mfma_f32_32x32x16_bf16 v[176:191], a[120:123], a[12:15], v[176:191]
  s_nop 0
  v_add_f32 v145, v145, v149
  v_add_f32 v146, v146, v150
  v_add_f32 v147, v147, v151
  v_add_f32 v152, v152, v156
  v_add_f32 v153, v153, v157
  v_add_f32 v154, v154, v158
  v_add_f32 v155, v155, v159
  v_add_f32 v144, v144, v152
  v_add_f32 v145, v145, v153
  v_add_f32 v146, v146, v154
  v_add_f32 v147, v147, v155
  v_cvt_pk_bf16_f32 v144, v144, v145
  v_cvt_pk_bf16_f32 v146, v146, v147
  v_mfma_f32_32x32x16_bf16 v[192:207], a[124:127], a[8:11], v[192:207]
  buffer_load_dwordx4 a[8:11], v1, s[24:27], s65 offen offset:2048 sc1
  v_mov_b32 v145, v51
  v_mov_b32 v147, v51
  v_mfma_f32_32x32x16_bf16 v[208:223], a[124:127], a[12:15], v[208:223]
  buffer_load_dwordx4 a[12:15], v1, s[24:27], s94 offen offset:2048 sc1
  s_waitcnt vmcnt(12)
  v_mfma_f32_32x32x16_bf16 v[160:175], v[224:227], a[16:19], v[160:175]
  buffer_store_dwordx4 v[144:147], v1, s[24:27], s82 offen offset:1024 sc1
  ds_read_b64_tr_b16 a[144:145], v57 offset:8192
  ds_read_b64_tr_b16 a[146:147], v57 offset:8704
  ds_read_b64_tr_b16 a[148:149], v58 offset:8192
  ds_read_b64_tr_b16 a[150:151], v58 offset:8704
  v_add_f32 v84, v84, v88
  v_add_f32 v85, v85, v89
  v_add_f32 v86, v86, v90
  v_add_f32 v87, v87, v91
  v_add_f32 v92, v92, v96
  v_add_f32 v93, v93, v97
  s_waitcnt vmcnt(12)
  v_mfma_f32_32x32x16_bf16 v[176:191], v[224:227], a[20:23], v[176:191]
  s_nop 0
  v_add_f32 v94, v94, v98
  v_add_f32 v95, v95, v99
  v_add_f32 v84, v84, v92
  v_add_f32 v85, v85, v93
  v_add_f32 v86, v86, v94
  v_add_f32 v87, v87, v95
  v_cvt_pk_bf16_f32 v84, v84, v85
  v_cvt_pk_bf16_f32 v86, v86, v87
  v_mov_b32 v85, v51
  v_mov_b32 v87, v51
  v_mfma_f32_32x32x16_bf16 v[192:207], v[228:231], a[16:19], v[192:207]
  s_xor_b32 s65, s96, 40960
  buffer_load_dwordx4 a[16:19], v1, s[24:27], s65 offen offset:0 sc1
  v_mfma_f32_32x32x16_bf16 v[208:223], v[228:231], a[20:23], v[208:223]
  s_xor_b32 s94, s96, 303104
  buffer_load_dwordx4 a[20:23], v1, s[24:27], s94 offen offset:0 sc1
  s_waitcnt vmcnt(13)
  v_mfma_f32_32x32x16_bf16 v[160:175], v[232:235], a[24:27], v[160:175]
  buffer_store_dwordx4 v[84:87], v1, s[24:27], s82 offen offset:2048 sc1
  ds_read_b64_tr_b16 a[152:153], v57 offset:10240
  s_waitcnt lgkmcnt(1)
  ds_read_b64_tr_b16 a[154:155], v57 offset:10752
  ds_read_b64_tr_b16 a[156:157], v58 offset:10240
  ds_read_b64_tr_b16 a[158:159], v58 offset:10752
  v_add_f32 v14, v14, v18
  s_waitcnt vmcnt(13)
  v_mfma_f32_32x32x16_bf16 v[176:191], v[232:235], a[28:31], v[176:191]
  s_nop 0
  v_add_f32 v15, v15, v19
  v_add_f32 v16, v16, v20
  v_add_f32 v17, v17, v21
  v_add_f32 v22, v22, v26
  v_add_f32 v23, v23, v27
  v_add_f32 v24, v24, v28
  v_add_f32 v25, v25, v29
  v_add_f32 v14, v14, v22
  v_add_f32 v15, v15, v23
  v_mfma_f32_32x32x16_bf16 v[192:207], v[236:239], a[24:27], v[192:207]
  buffer_load_dwordx4 a[24:27], v1, s[24:27], s65 offen offset:1024 sc1
  v_add_f32 v16, v16, v24
  v_add_f32 v17, v17, v25
  v_cvt_pk_bf16_f32 v14, v14, v15
  v_cvt_pk_bf16_f32 v16, v16, v17
  v_mov_b32 v15, v51
  v_mfma_f32_32x32x16_bf16 v[208:223], v[236:239], a[28:31], v[208:223]
  buffer_load_dwordx4 a[28:31], v1, s[24:27], s94 offen offset:1024 sc1
  v_mov_b32 v17, v51
  s_waitcnt vmcnt(14)
  v_mfma_f32_32x32x16_bf16 v[160:175], v[240:243], a[32:35], v[160:175]
  buffer_store_dwordx4 v[14:17], v1, s[24:27], s82 offen offset:3072 sc1
  ds_read_b64_tr_b16 a[160:161], v57 offset:18432
  ds_read_b64_tr_b16 a[162:163], v57 offset:18944
  ds_read_b64_tr_b16 a[164:165], v58 offset:18432
  s_waitcnt vmcnt(14)
  v_mfma_f32_32x32x16_bf16 v[176:191], v[240:243], a[36:39], v[176:191]
  ds_read_b64_tr_b16 a[166:167], v58 offset:18944
  ds_read_b64_tr_b16 a[168:169], v57 offset:12288
  ds_read_b64_tr_b16 a[170:171], v57 offset:12800
  ds_read_b64_tr_b16 a[172:173], v58 offset:12288
  v_mfma_f32_32x32x16_bf16 v[192:207], v[244:247], a[32:35], v[192:207]
  buffer_load_dwordx4 a[32:35], v1, s[24:27], s65 offen offset:2048 sc1
  ds_read_b64_tr_b16 a[174:175], v58 offset:12800
  v_mfma_f32_32x32x16_bf16 v[208:223], v[244:247], a[36:39], v[208:223]
  buffer_load_dwordx4 a[36:39], v1, s[24:27], s94 offen offset:2048 sc1
  s_barrier
  s_waitcnt vmcnt(15)
  v_mfma_f32_32x32x16_bf16 v[160:175], v[248:251], a[40:43], v[160:175]
  ds_read_b64_tr_b16 a[176:177], v57 offset:14336
  ds_read_b64_tr_b16 a[178:179], v57 offset:14848
  ds_read_b64_tr_b16 a[180:181], v58 offset:14336
  s_waitcnt lgkmcnt(8)
  ds_read_b64_tr_b16 a[182:183], v58 offset:14848
  s_waitcnt vmcnt(14)
  v_mfma_f32_32x32x16_bf16 v[176:191], v[248:251], a[44:47], v[176:191]
  v_mfma_f32_32x32x16_bf16 v[192:207], v[252:255], a[40:43], v[192:207]
  s_xor_b32 s65, s96, 57344
  buffer_load_dwordx4 a[40:43], v1, s[24:27], s65 offen offset:0 sc1
  v_mfma_f32_32x32x16_bf16 v[208:223], v[252:255], a[44:47], v[208:223]
  s_xor_b32 s94, s96, 319488
  buffer_load_dwordx4 a[44:47], v1, s[24:27], s94 offen offset:0 sc1
  s_waitcnt vmcnt(15)
  v_mfma_f32_32x32x16_bf16 v[160:175], a[128:131], a[0:3], v[160:175]
  ds_read_b64_tr_b16 a[184:185], v57 offset:16384
  ds_read_b64_tr_b16 a[186:187], v57 offset:16896
  ds_read_b64_tr_b16 a[188:189], v58 offset:16384
  ds_read_b64_tr_b16 a[190:191], v58 offset:16896
  s_waitcnt vmcnt(14)
  v_mfma_f32_32x32x16_bf16 v[176:191], a[128:131], a[4:7], v[176:191]
  v_mfma_f32_32x32x16_bf16 v[192:207], a[132:135], a[0:3], v[192:207]
  buffer_load_dwordx4 a[0:3], v1, s[24:27], s65 offen offset:1024 sc1
  v_mfma_f32_32x32x16_bf16 v[208:223], a[132:135], a[4:7], v[208:223]
  buffer_load_dwordx4 a[4:7], v1, s[24:27], s94 offen offset:1024 sc1
  s_waitcnt vmcnt(14)
  v_mfma_f32_32x32x16_bf16 v[160:175], a[136:139], a[8:11], v[160:175]
  s_waitcnt vmcnt(13)
  v_mfma_f32_32x32x16_bf16 v[176:191], a[136:139], a[12:15], v[176:191]
  v_mfma_f32_32x32x16_bf16 v[192:207], a[140:143], a[8:11], v[192:207]
  buffer_load_dwordx4 a[8:11], v1, s[24:27], s65 offen offset:2048 sc1
  v_mfma_f32_32x32x16_bf16 v[208:223], a[140:143], a[12:15], v[208:223]
  buffer_load_dwordx4 a[12:15], v1, s[24:27], s94 offen offset:2048 sc1
  s_waitcnt vmcnt(13)
  v_mfma_f32_32x32x16_bf16 v[160:175], a[144:147], a[16:19], v[160:175]
  s_waitcnt vmcnt(12)
  v_mfma_f32_32x32x16_bf16 v[176:191], a[144:147], a[20:23], v[176:191]
  v_mfma_f32_32x32x16_bf16 v[192:207], a[148:151], a[16:19], v[192:207]
  v_mfma_f32_32x32x16_bf16 v[208:223], a[148:151], a[20:23], v[208:223]
  s_waitcnt vmcnt(10)
  v_mfma_f32_32x32x16_bf16 v[160:175], a[152:155], a[24:27], v[160:175]
  buffer_load_dwordx4 v[132:135], v1, s[24:27], s98 offen offset:0 sc1
  s_waitcnt vmcnt(10)
  v_mfma_f32_32x32x16_bf16 v[176:191], a[152:155], a[28:31], v[176:191]
  buffer_load_dwordx4 v[148:151], v1, s[24:27], s98 offen offset:1024 sc1
  v_mfma_f32_32x32x16_bf16 v[192:207], a[156:159], a[24:27], v[192:207]
  buffer_load_dwordx4 v[88:91], v1, s[24:27], s98 offen offset:2048 sc1
  v_mfma_f32_32x32x16_bf16 v[208:223], a[156:159], a[28:31], v[208:223]
  buffer_load_dwordx4 v[18:21], v1, s[24:27], s98 offen offset:3072 sc1
  s_waitcnt vmcnt(11)
  v_mfma_f32_32x32x16_bf16 v[160:175], a[160:163], a[32:35], v[160:175]
  s_waitcnt vmcnt(10)
  v_mfma_f32_32x32x16_bf16 v[176:191], a[160:163], a[36:39], v[176:191]
  s_waitcnt vmcnt(9) lgkmcnt(0)
  v_mfma_f32_32x32x16_bf16 v[160:175], a[168:171], a[40:43], v[160:175]
  s_waitcnt vmcnt(8)
  v_mfma_f32_32x32x16_bf16 v[176:191], a[168:171], a[44:47], v[176:191]
  s_waitcnt vmcnt(7)
  v_mfma_f32_32x32x16_bf16 v[160:175], a[176:179], a[0:3], v[160:175]
  s_waitcnt vmcnt(6)
  v_mfma_f32_32x32x16_bf16 v[176:191], a[176:179], a[4:7], v[176:191]
  s_waitcnt vmcnt(5)
  v_mfma_f32_32x32x16_bf16 v[160:175], a[184:187], a[8:11], v[160:175]
  s_waitcnt vmcnt(4)
  v_mfma_f32_32x32x16_bf16 v[176:191], a[184:187], a[12:15], v[176:191]
  v_mfma_f32_32x32x16_bf16 v[192:207], a[164:167], a[32:35], v[192:207]
  s_nop 8
  ds_write_b128 v76, v[160:163] offset:0
  v_mfma_f32_32x32x16_bf16 v[208:223], a[164:167], a[36:39], v[208:223]
  ds_write_b128 v78, v[164:167] offset:0
  v_mfma_f32_32x32x16_bf16 v[192:207], a[172:175], a[40:43], v[192:207]
  ds_write_b128 v79, v[168:171] offset:0
  v_mfma_f32_32x32x16_bf16 v[208:223], a[172:175], a[44:47], v[208:223]
  ds_write_b128 v80, v[172:175] offset:0
  v_mfma_f32_32x32x16_bf16 v[192:207], a[180:183], a[0:3], v[192:207]
  ds_write_b128 v76, v[176:179] offset:8192
  v_mfma_f32_32x32x16_bf16 v[208:223], a[180:183], a[4:7], v[208:223]
  ds_write_b128 v78, v[180:183] offset:8192
  v_mfma_f32_32x32x16_bf16 v[192:207], a[188:191], a[8:11], v[192:207]
  ds_write_b128 v79, v[184:187] offset:8192
  v_mfma_f32_32x32x16_bf16 v[208:223], a[188:191], a[12:15], v[208:223]
  ds_write_b128 v80, v[188:191] offset:8192
  s_nop 8
  ds_write_b128 v76, v[192:195] offset:128
  ds_write_b128 v78, v[196:199] offset:128
  ds_write_b128 v79, v[200:203] offset:128
  ds_write_b128 v80, v[204:207] offset:128
  ds_write_b128 v76, v[208:211] offset:8320
  ds_write_b128 v78, v[212:215] offset:8320
  ds_write_b128 v79, v[216:219] offset:8320
  s_waitcnt lgkmcnt(10)
  ds_write_b128 v80, v[220:223] offset:8320
  s_waitcnt lgkmcnt(0)
  s_barrier
  ds_read_b128 v[160:163], v77 offset:0
  ds_read_b128 v[164:167], v77 offset:16384
  ds_read_b128 v[168:171], v77 offset:32768
  ds_read_b128 v[172:175], v77 offset:49152
  ds_read_b128 v[176:179], v77 offset:1024
  ds_read_b128 v[180:183], v77 offset:17408
  ds_read_b128 v[184:187], v77 offset:33792
  ds_read_b128 v[188:191], v77 offset:50176
  ds_read_b128 v[192:195], v77 offset:2048
  ds_read_b128 v[196:199], v77 offset:18432
  ds_read_b128 v[200:203], v77 offset:34816
  ds_read_b128 v[204:207], v77 offset:51200
  ds_read_b128 v[208:211], v77 offset:3072
  ds_read_b128 v[212:215], v77 offset:19456
  ds_read_b128 v[216:219], v77 offset:35840
  s_waitcnt lgkmcnt(14)
  ds_read_b128 v[220:223], v77 offset:52224
  s_waitcnt vmcnt(0)
  v_xor_b32 v136, v51, v133
  v_xor_b32 v137, v51, v135
  v_xor_b32 v152, v51, v149
  v_xor_b32 v153, v51, v151
  v_xor_b32 v92, v51, v89
  v_xor_b32 v93, v51, v91
  v_xor_b32 v22, v51, v19
  v_xor_b32 v23, v51, v21
  v_or3_b32 v136, v136, v137, v152
  v_or3_b32 v92, v92, v93, v153
  v_or3_b32 v136, v136, v22, v23
  v_or_b32 v136, v136, v92
  v_cmp_ne_u32 vcc, 0, v136
  s_and_b64 vcc, exec, vcc
  s_cbranch_vccz L_ok4
  s_mov_b32 s71, 30000
L_sp4:
  s_sleep 1
  buffer_load_dwordx4 v[132:135], v1, s[24:27], s98 offen offset:0 sc1
  buffer_load_dwordx4 v[148:151], v1, s[24:27], s98 offen offset:1024 sc1
  buffer_load_dwordx4 v[88:91], v1, s[24:27], s98 offen offset:2048 sc1
  buffer_load_dwordx4 v[18:21], v1, s[24:27], s98 offen offset:3072 sc1
  s_waitcnt vmcnt(0)
  v_xor_b32 v136, v51, v133
  v_xor_b32 v137, v51, v135
  v_xor_b32 v152, v51, v149
  v_xor_b32 v153, v51, v151
  v_xor_b32 v92, v51, v89
  v_xor_b32 v93, v51, v91
  v_xor_b32 v22, v51, v19
  v_xor_b32 v23, v51, v21
  v_or3_b32 v136, v136, v137, v152
  v_or3_b32 v92, v92, v93, v153
  v_or3_b32 v136, v136, v22, v23
  v_or_b32 v136, v136, v92
  v_cmp_ne_u32 vcc, 0, v136
  s_and_b64 vcc, exec, vcc
  s_cbranch_vccz L_ok4
  s_sub_u32 s71, s71, 1
  s_cmp_lg_u32 s71, 0
  s_cbranch_scc1 L_sp4
L_ok4:
  v_lshlrev_b32 v133, 16, v132
  v_and_b32 v132, 0xffff0000, v132
  v_lshlrev_b32 v135, 16, v134
  v_and_b32 v134, 0xffff0000, v134
  v_add_f32 v112, v112, v133
  v_add_f32 v113, v113, v132
  v_add_f32 v114, v114, v135
  v_add_f32 v115, v115, v134
  v_lshlrev_b32 v149, 16, v148
  v_and_b32 v148, 0xffff0000, v148
  v_lshlrev_b32 v151, 16, v150
  v_and_b32 v150, 0xffff0000, v150
  v_add_f32 v116, v116, v149
  v_add_f32 v117, v117, v148
  v_add_f32 v118, v118, v151
  v_add_f32 v119, v119, v150
  v_lshlrev_b32 v89, 16, v88
  v_and_b32 v88, 0xffff0000, v88
  v_lshlrev_b32 v91, 16, v90
  v_and_b32 v90, 0xffff0000, v90
  v_add_f32 v120, v120, v89
  v_add_f32 v121, v121, v88
  v_add_f32 v122, v122, v91
  v_add_f32 v123, v123, v90
  v_lshlrev_b32 v19, 16, v18
  v_and_b32 v18, 0xffff0000, v18
  v_lshlrev_b32 v21, 16, v20
  v_and_b32 v20, 0xffff0000, v20
  v_add_f32 v124, v124, v19
  v_add_f32 v125, v125, v18
  v_add_f32 v126, v126, v21
  v_add_f32 v127, v127, v20
  s_waitcnt lgkmcnt(0)
  v_add_f32 v160, v160, v164
  v_add_f32 v161, v161, v165
  v_add_f32 v162, v162, v166
  v_add_f32 v163, v163, v167
  v_add_f32 v168, v168, v172
  v_add_f32 v169, v169, v173
  v_add_f32 v170, v170, v174
  v_add_f32 v171, v171, v175
  v_add_f32 v160, v160, v112
  v_add_f32 v161, v161, v113
  v_add_f32 v162, v162, v114
  v_add_f32 v163, v163, v115
  v_add_f32 v160, v160, v168
  v_add_f32 v161, v161, v169
  v_add_f32 v162, v162, v170
  v_add_f32 v163, v163, v171
  s_add_u32 s68, s58, 0
  buffer_store_dwordx4 v[160:163], v72, s[40:43], s68 offen sc1
  v_add_f32 v176, v176, v180
  v_add_f32 v177, v177, v181
  v_add_f32 v178, v178, v182
  v_add_f32 v179, v179, v183
  v_add_f32 v184, v184, v188
  v_add_f32 v185, v185, v189
  v_add_f32 v186, v186, v190
  v_add_f32 v187, v187, v191
  v_add_f32 v176, v176, v116
  v_add_f32 v177, v177, v117
  v_add_f32 v178, v178, v118
  v_add_f32 v179, v179, v119
  v_add_f32 v176, v176, v184
  v_add_f32 v177, v177, v185
  v_add_f32 v178, v178, v186
  v_add_f32 v179, v179, v187
  s_add_u32 s68, s58, 8192
  buffer_store_dwordx4 v[176:179], v72, s[40:43], s68 offen sc1
  v_add_f32 v192, v192, v196
  v_add_f32 v193, v193, v197
  v_add_f32 v194, v194, v198
  v_add_f32 v195, v195, v199
  v_add_f32 v200, v200, v204
  v_add_f32 v201, v201, v205
  v_add_f32 v202, v202, v206
  v_add_f32 v203, v203, v207
  v_add_f32 v192, v192, v120
  v_add_f32 v193, v193, v121
  v_add_f32 v194, v194, v122
  v_add_f32 v195, v195, v123
  v_add_f32 v192, v192, v200
  v_add_f32 v193, v193, v201
  v_add_f32 v194, v194, v202
  v_add_f32 v195, v195, v203
  s_add_u32 s68, s58, 16384
  buffer_store_dwordx4 v[192:195], v72, s[40:43], s68 offen sc1
  v_add_f32 v208, v208, v212
  v_add_f32 v209, v209, v213
  v_add_f32 v210, v210, v214
  v_add_f32 v211, v211, v215
  v_add_f32 v216, v216, v220
  v_add_f32 v217, v217, v221
  v_add_f32 v218, v218, v222
  v_add_f32 v219, v219, v223
  v_add_f32 v208, v208, v124
  v_add_f32 v209, v209, v125
  v_add_f32 v210, v210, v126
  v_add_f32 v211, v211, v127
  v_add_f32 v208, v208, v216
  v_add_f32 v209, v209, v217
  v_add_f32 v210, v210, v218
  v_add_f32 v211, v211, v219
  s_add_u32 s68, s58, 24576
  buffer_store_dwordx4 v[208:211], v72, s[40:43], s68 offen sc1
L_end:
  s_endpgm
L_codeend:
.section .rodata,"a"
.p2align 6
.amdhsa_kernel parallel_sum__ssm_conv_s5__glu_gated_glu__prompt_kernel
  .amdhsa_next_free_vgpr 512
  .amdhsa_next_free_sgpr 102
  .amdhsa_accum_offset 256
  .amdhsa_group_segment_fixed_size 0
  .amdhsa_kernarg_size 128
  .amdhsa_user_sgpr_count 2
  .amdhsa_user_sgpr_kernarg_segment_ptr 1
  .amdhsa_system_sgpr_workgroup_id_x 1
.end_amdhsa_kernel
```
